```python
import torch

def _softmax(x, axis=-1):
    return torch.softmax(x, dim=axis)
def _gelu(x):
    return torch.nn.functional.gelu(x, approximate="tanh")
def _silu(x):
    return torch.nn.functional.silu(x)
def _sigmoid(x):
    return torch.sigmoid(x)
def _layernorm(x, axis=-1, eps=1e-5):
    m = x.mean(dim=axis, keepdim=True)
    v = x.var(dim=axis, keepdim=True, unbiased=False)
    return (x - m) / torch.sqrt(v + eps)
def _scatter_add(tgt, idx, src, axis=0):
    return tgt.clone().index_add_(axis, idx, src)
def _segment_sum(src, seg, n):
    out = torch.zeros((n,) + src.shape[1:], dtype=src.dtype)
    return out.index_add_(0, seg, src)
def _pad(x, pw):
    flat = tuple(v for pair in reversed(pw) for v in pair)
    return torch.nn.functional.pad(x, flat)

kernel_name = 'gated_mix__gqa_block_cached__swiglu_ffn__decode'

def setup_inputs():

    _w = (lambda a: (lambda t: t.to(torch.bfloat16) if t.is_floating_point() else t)(torch.as_tensor(a)))
    def _A_setup():
        B, Sq, D = 2, 1, 576
        Hq, Hkv, Sk, Dh = 32, 16, 4096, 128
        assert Hq % Hkv == 0, (Hq, Hkv)
        return {
            "x": _w((lambda *s: torch.randn(*s, dtype=torch.bfloat16) * 0.05)(B, Sq, D)),
            "k_cache": _w((lambda *s: torch.randn(*s, dtype=torch.bfloat16) * 6.4)(B, Hkv, Sk, Dh)),
            "v_cache": _w((lambda *s: torch.randn(*s, dtype=torch.bfloat16) * 0.8)(B, Hkv, Sk, Dh)),
            "wq": _w((lambda *s: torch.randn(*s, dtype=torch.bfloat16) * 6.4)(D, Hq * Dh) * (D ** -0.5)),
            "wo": _w((lambda *s: torch.randn(*s, dtype=torch.bfloat16) * 0.8)(Hq * Dh, D) * ((Hq * Dh) ** -0.5)),
        }
    _A_in = _A_setup()

    def _B_setup():
        B, S, D, F = 2, 1, 576, 4608
        return {
            "x": _w((lambda *s: torch.randn(*s, dtype=torch.bfloat16) * 0.05)(B, S, D)),
            "w_gate": _w((lambda *s: torch.randn(*s, dtype=torch.bfloat16) * 0.2)(D, F)),
            "w_up": _w((lambda *s: torch.randn(*s, dtype=torch.bfloat16) * 0.2)(D, F)),
            "w_down": _w((lambda *s: torch.randn(*s, dtype=torch.bfloat16) * 0.2)(F, D)),
        }
    _B_in = _B_setup()

    return {
        "A_x": _A_in["x"],
        "A_k_cache": _A_in["k_cache"],
        "A_v_cache": _A_in["v_cache"],
        "A_wq": _A_in["wq"],
        "A_wo": _A_in["wo"],
        "B_x": _B_in["x"],
        "B_w_gate": _B_in["w_gate"],
        "B_w_up": _B_in["w_up"],
        "B_w_down": _B_in["w_down"],
        "gate_w": _w((lambda *s: torch.randn(*s, dtype=torch.bfloat16) * 0.05)(576) * 16.0),
    }

def reference(A_x, A_k_cache, A_v_cache, A_wq, A_wo, B_x, B_w_gate, B_w_up, B_w_down, gate_w):
    def _A_ref(x, k_cache, v_cache, wq, wo):
        B, Sq, D = x.shape
        Hq, Dh = 32, 128
        Hkv = k_cache.shape[1]
        rep = Hq // Hkv
        q = (lambda x, *d: x.permute(*d))((x @ wq).reshape(B, Sq, Hq, Dh), 0, 2, 1, 3)
        k = (lambda x, n, axis: torch.repeat_interleave(x, n, dim=axis))(k_cache, rep, axis=1)
        v = (lambda x, n, axis: torch.repeat_interleave(x, n, dim=axis))(v_cache, rep, axis=1)
        scores = torch.einsum("bhqd,bhkd->bhqk", q, k) * (Dh ** -0.5)
        p = _softmax(scores, axis=-1)
        o = torch.einsum("bhqk,bhkd->bhqd", p, v)
        return (lambda x, *d: x.permute(*d))(o, 0, 2, 1, 3).reshape(B, Sq, Hq * Dh) @ wo

    def _B_ref(x, w_gate, w_up, w_down):
        g = _silu(x @ w_gate)
        u = x @ w_up
        return (g * u) @ w_down

    x = A_x
    g = _sigmoid((x * gate_w).sum(-1, keepdims=True))
    a = _A_ref(x, A_k_cache, A_v_cache, A_wq, A_wo)
    b = _B_ref(x, B_w_gate, B_w_up, B_w_down)
    return g * a + (1 - g) * b
```

```asm
; @launch grid=(256,1,1) block=(768,1,1) lds=16384
.amdgcn_target "amdgcn-amd-amdhsa--gfx950"
.text
.globl gated_mix__gqa_block_cached__swiglu_ffn__decode_kernel
.p2align 8
.type gated_mix__gqa_block_cached__swiglu_ffn__decode_kernel,@function
gated_mix__gqa_block_cached__swiglu_ffn__decode_kernel:
    s_cmp_ge_u32 s2, 256
    s_cbranch_scc1 L_end
    s_load_dwordx16 s[36:51], s[0:1], 0
    s_load_dwordx8 s[52:59], s[0:1], 64
    s_load_dwordx2 s[60:61], s[0:1], 96
    v_lshrrev_b32 v1, 6, v0
    v_and_b32 v0, 63, v0
    s_nop 0
    v_readfirstlane_b32 s3, v1
    v_mov_b32 v1, 0
    v_mov_b32 v2, 1
    s_and_b32 s4, s2, 7
    s_lshr_b32 s5, s2, 3
    s_lshr_b32 s76, s2, 4
    s_and_b32 s77, s2, 15
    s_bfe_u32 s90, s2, 0x20001
    s_lshl_b32 s90, s90, 1
    s_bfe_u32 s6, s2, 0x10003
    s_add_u32 s90, s90, s6
    s_lshl_b32 s6, s76, 3
    s_add_u32 s90, s90, s6
    s_mov_b32 s74, 0x05040100
    s_mov_b32 s75, 0x07060302
    s_mov_b32 s78, 0xfffffffe
    s_cmp_lt_u32 s5, 18
    s_cbranch_scc0 L_1
    s_mov_b32 s62, 0
    s_mul_i32 s63, s4, 18
    s_add_u32 s63, s63, s5
    s_add_u32 s64, s63, 64
    s_branch L_3
L_1:
    s_cmp_lt_u32 s5, 26
    s_cbranch_scc0 L_2
    s_mov_b32 s62, 1
    s_lshl_b32 s63, s4, 3
    s_add_u32 s63, s63, s5
    s_sub_u32 s63, s63, 18
    s_mov_b32 s64, s63
    s_branch L_3
L_2:
    s_sub_u32 s63, s5, 26
    s_lshl_b32 s63, s63, 3
    s_add_u32 s63, s63, s4
    s_mov_b32 s64, 0
    s_cmp_lt_u32 s63, 36
    s_cselect_b32 s62, 2, 3
L_3:
    s_lshl_b32 s69, s64, 7
    s_add_u32 s69, s69, 655360
    s_waitcnt lgkmcnt(0)
    s_mov_b32 s8, s36
    s_mov_b32 s9, s37
    s_mov_b32 s10, 2304
    s_mov_b32 s11, 0x20000
    s_mov_b32 s12, s60
    s_mov_b32 s13, s61
    s_mov_b32 s14, 268435456
    s_mov_b32 s15, 0x20000
    s_mov_b32 s28, s58
    s_mov_b32 s29, s59
    s_mov_b32 s30, 256
    s_mov_b32 s31, 0x20000
    s_cmp_ge_u32 s3, 4
    s_cbranch_scc1 L_att
    s_cmp_eq_u32 s3, 1
    s_cbranch_scc1 L_x1
    s_setprio 3
    s_mov_b32 s79, s3
    s_cmp_eq_u32 s3, 0
    s_cbranch_scc0 L_4
    s_mov_b32 s16, s42
    s_mov_b32 s17, s43
    s_mov_b32 s18, 4718592
    s_mov_b32 s19, 0x20000
    s_mov_b32 s96, 8192
    s_and_b32 s6, s2, 7
    s_mul_i32 s100, s6, 144
    s_mul_i32 s97, s6, 589824
    s_lshl_b32 s98, s6, 15
    s_lshr_b32 s6, s2, 3
    s_lshl_b32 s7, s6, 8
    s_add_u32 s97, s97, s7
    s_lshl_b32 s7, s6, 9
    s_add_u32 s98, s98, s7
    s_add_u32 s98, s98, 1703936
    s_mov_b32 s99, 16384
    s_branch L_job
L_4:
    s_sub_u32 s66, s3, 2
    s_lshl_b32 s66, s66, 8
    s_add_u32 s66, s66, s2
    s_cmp_ge_u32 s66, 288
    s_cbranch_scc1 L_5
    s_mov_b32 s16, s48
    s_mov_b32 s17, s49
    s_mov_b32 s18, 5308416
    s_mov_b32 s19, 0x20000
    s_mov_b32 s98, 1966080
    s_branch L_6
L_5:
    s_mov_b32 s16, s50
    s_mov_b32 s17, s51
    s_mov_b32 s18, 5308416
    s_mov_b32 s19, 0x20000
    s_mov_b32 s98, 2260992
    s_sub_u32 s66, s66, 288
L_6:
    s_mov_b32 s96, 9216
    s_and_b32 s6, s66, 7
    s_mul_i32 s100, s6, 144
    s_mul_i32 s97, s6, 663552
    s_mul_i32 s6, s6, 36864
    s_add_u32 s98, s98, s6
    s_lshr_b32 s6, s66, 3
    s_lshl_b32 s7, s6, 8
    s_add_u32 s97, s97, s7
    s_lshl_b32 s7, s6, 9
    s_add_u32 s98, s98, s7
    s_mov_b32 s99, 18432
    s_barrier
    s_cmp_eq_u32 s3, 3
    s_cbranch_scc0 L_job
    s_mov_b32 s65, 0
W_7:
    ds_read_b32 v10, v1 offset:8
    s_waitcnt lgkmcnt(0)
    v_readfirstlane_b32 s6, v10
    s_cmp_ge_u32 s6, 8
    s_cbranch_scc1 WD_8
    s_add_u32 s65, s65, 1
    s_cmp_gt_u32 s65, 400000
    s_cbranch_scc1 WD_8
    s_sleep 1
    s_branch W_7
WD_8:
    s_branch L_job
L_x1:
    s_setprio 3
    v_lshlrev_b32 v3, 2, v0
    ds_write_b32 v3, v1
    v_mov_b32 v16, -1
    v_mov_b32 v17, -1
    v_mov_b32 v18, -1
    v_mov_b32 v19, -1
    v_lshrrev_b32 v4, 5, v0
    v_and_b32 v5, 31, v0
    v_lshlrev_b32 v5, 4, v5
    s_mov_b32 s16, s42
    s_mov_b32 s17, s43
    s_mov_b32 s18, 4718592
    s_mov_b32 s19, 0x20000
    s_mov_b32 s96, 8192
    s_and_b32 s6, s2, 7
    s_mul_i32 s100, s6, 144
    s_mul_i32 s97, s6, 589824
    s_lshl_b32 s98, s6, 15
    s_lshr_b32 s6, s2, 3
    s_lshl_b32 s7, s6, 8
    s_add_u32 s97, s97, s7
    s_lshl_b32 s7, s6, 9
    s_add_u32 s98, s98, s7
    s_add_u32 s98, s98, 1703936
    s_mov_b32 s99, 16384
    v_mul_lo_u32 v6, v4, s99
    v_add_u32 v6, v6, v5
    buffer_store_dwordx4 v[16:19], v6, s[12:15], s98 offen sc1
    s_add_u32 s66, s2, 0
    s_cmp_ge_u32 s66, 288
    s_cbranch_scc1 L_9
    s_mov_b32 s98, 1966080
    s_branch L_10
L_9:
    s_mov_b32 s98, 2260992
    s_sub_u32 s66, s66, 288
L_10:
    s_mov_b32 s96, 9216
    s_and_b32 s6, s66, 7
    s_mul_i32 s100, s6, 144
    s_mul_i32 s97, s6, 663552
    s_mul_i32 s6, s6, 36864
    s_add_u32 s98, s98, s6
    s_lshr_b32 s6, s66, 3
    s_lshl_b32 s7, s6, 8
    s_add_u32 s97, s97, s7
    s_lshl_b32 s7, s6, 9
    s_add_u32 s98, s98, s7
    s_mov_b32 s99, 18432
    v_mul_lo_u32 v6, v4, s99
    v_add_u32 v6, v6, v5
    buffer_store_dwordx4 v[16:19], v6, s[12:15], s98 offen sc1
    s_add_u32 s66, s2, 256
    s_cmp_ge_u32 s66, 288
    s_cbranch_scc1 L_11
    s_mov_b32 s98, 1966080
    s_branch L_12
L_11:
    s_mov_b32 s98, 2260992
    s_sub_u32 s66, s66, 288
L_12:
    s_mov_b32 s96, 9216
    s_and_b32 s6, s66, 7
    s_mul_i32 s100, s6, 144
    s_mul_i32 s97, s6, 663552
    s_mul_i32 s6, s6, 36864
    s_add_u32 s98, s98, s6
    s_lshr_b32 s6, s66, 3
    s_lshl_b32 s7, s6, 8
    s_add_u32 s97, s97, s7
    s_lshl_b32 s7, s6, 9
    s_add_u32 s98, s98, s7
    s_mov_b32 s99, 18432
    v_mul_lo_u32 v6, v4, s99
    v_add_u32 v6, v6, v5
    buffer_store_dwordx4 v[16:19], v6, s[12:15], s98 offen sc1
    s_cmp_ge_u32 s2, 64
    s_cbranch_scc1 L_13
    s_add_u32 s66, s2, 512
    s_cmp_ge_u32 s66, 288
    s_cbranch_scc1 L_14
    s_mov_b32 s98, 1966080
    s_branch L_15
L_14:
    s_mov_b32 s98, 2260992
    s_sub_u32 s66, s66, 288
L_15:
    s_mov_b32 s96, 9216
    s_and_b32 s6, s66, 7
    s_mul_i32 s100, s6, 144
    s_mul_i32 s97, s6, 663552
    s_mul_i32 s6, s6, 36864
    s_add_u32 s98, s98, s6
    s_lshr_b32 s6, s66, 3
    s_lshl_b32 s7, s6, 8
    s_add_u32 s97, s97, s7
    s_lshl_b32 s7, s6, 9
    s_add_u32 s98, s98, s7
    s_mov_b32 s99, 18432
    v_mul_lo_u32 v6, v4, s99
    v_add_u32 v6, v6, v5
    buffer_store_dwordx4 v[16:19], v6, s[12:15], s98 offen sc1
L_13:
    v_lshrrev_b32 v9, 4, v0
    v_lshlrev_b32 v9, 13, v9
    v_and_b32 v10, 15, v0
    v_lshl_add_u32 v9, v10, 4, v9
    s_lshl_b32 s68, s76, 15
    s_lshl_b32 s6, s77, 9
    s_add_u32 s68, s68, s6
    s_add_u32 s68, s68, 65536
    buffer_store_dwordx4 v[16:19], v9, s[12:15], s68 offen sc1
    buffer_store_dwordx4 v[16:19], v9, s[12:15], s68 offen offset:256 sc1
    v_lshlrev_b32 v9, 8, v0
    s_lshl_b32 s68, s76, 9
    s_lshl_b32 s6, s77, 4
    s_add_u32 s68, s68, s6
    s_add_u32 s68, s68, 589824
    s_mov_b64 exec, 3
    buffer_store_dwordx4 v[16:19], v9, s[12:15], s68 offen sc1
    s_mov_b64 exec, -1
    s_cmp_gt_u32 s62, 1
    s_cbranch_scc1 L_16
    v_lshrrev_b32 v9, 3, v0
    s_mov_b32 s6, 26624
    v_mul_lo_u32 v9, v9, s6
    v_and_b32 v10, 7, v0
    v_lshl_add_u32 v9, v10, 4, v9
    s_add_u32 s6, s69, 0
    buffer_store_dwordx4 v[16:19], v9, s[12:15], s6 offen sc1
    s_add_u32 s6, s69, 212992
    buffer_store_dwordx4 v[16:19], v9, s[12:15], s6 offen sc1
    s_add_u32 s6, s69, 425984
    buffer_store_dwordx4 v[16:19], v9, s[12:15], s6 offen sc1
    s_add_u32 s6, s69, 638976
    buffer_store_dwordx4 v[16:19], v9, s[12:15], s6 offen sc1
    s_mov_b32 exec_lo, -1
    s_mov_b32 exec_hi, 0
    s_add_u32 s6, s69, 851968
    buffer_store_dwordx4 v[16:19], v9, s[12:15], s6 offen sc1
    s_mov_b64 exec, -1
L_16:
    s_lshl_b32 s68, s2, 7
    s_add_u32 s68, s68, 1638400
    s_mov_b64 exec, 1
    buffer_store_dword v16, v1, s[12:15], s68 offen sc1
    s_mov_b64 exec, -1
    s_waitcnt lgkmcnt(0)
    s_barrier
    s_waitcnt vmcnt(0)
    s_mov_b64 s[70:71], exec
    s_mov_b64 exec, 1
    ds_add_u32 v1, v2 offset:0
    s_mov_b64 exec, s[70:71]
    s_lshl_b32 s6, s76, 4
    s_add_u32 s88, s58, s6
    s_addc_u32 s89, s59, 0
    s_mov_b32 s92, 1
    s_atomic_add s92, s[88:89], 0 glc
    s_waitcnt lgkmcnt(0)
    s_and_b32 s92, s92, 15
    s_cmp_eq_u32 s92, 15
    s_cbranch_scc0 L_17
    s_lshl_b32 s6, s76, 11
    s_add_u32 s6, s6, 1638400
    s_add_u32 s88, s60, s6
    s_addc_u32 s89, s61, 0
    s_mov_b32 s92, 2
    s_atomic_add s92, s[88:89], 0
    s_atomic_add s92, s[88:89], 128
    s_atomic_add s92, s[88:89], 256
    s_atomic_add s92, s[88:89], 384
    s_atomic_add s92, s[88:89], 512
    s_atomic_add s92, s[88:89], 640
    s_atomic_add s92, s[88:89], 768
    s_atomic_add s92, s[88:89], 896
    s_atomic_add s92, s[88:89], 1024
    s_atomic_add s92, s[88:89], 1152
    s_atomic_add s92, s[88:89], 1280
    s_atomic_add s92, s[88:89], 1408
    s_atomic_add s92, s[88:89], 1536
    s_atomic_add s92, s[88:89], 1664
    s_atomic_add s92, s[88:89], 1792
    s_atomic_add s92, s[88:89], 1920
    s_branch GD_18
L_17:
    s_add_u32 s88, s60, s68
    s_addc_u32 s89, s61, 0
    s_mov_b32 s65, 0
G_19:
    s_cmp_gt_u32 s65, 64
    s_cbranch_scc1 GV_20
    s_load_dword s6, s[88:89], 0 glc
    s_waitcnt lgkmcnt(0)
    s_branch GC_21
GV_20:
    buffer_load_dword v9, v1, s[12:15], s68 offen sc1
    s_waitcnt vmcnt(0)
    v_readfirstlane_b32 s6, v9
GC_21:
    s_cmp_eq_u32 s6, 1
    s_cbranch_scc1 GD_18
    s_add_u32 s65, s65, 1
    s_cmp_gt_u32 s65, 400000
    s_cbranch_scc1 GD_18
    s_sleep 2
    s_branch G_19
GD_18:
    s_lshl_b32 s6, s76, 10
    s_add_u32 s6, s6, 1703936
    s_add_u32 s88, s60, s6
    s_addc_u32 s89, s61, 0
    s_mov_b32 s65, 0
Q_22:
    s_load_dword s36, s[88:89], 16892 glc
    s_load_dword s37, s[88:89], 17404 glc
    s_load_dword s38, s[88:89], 49660 glc
    s_load_dword s39, s[88:89], 50172 glc
    s_load_dword s40, s[88:89], 82428 glc
    s_load_dword s41, s[88:89], 82940 glc
    s_load_dword s42, s[88:89], 115196 glc
    s_load_dword s43, s[88:89], 115708 glc
    s_load_dword s46, s[88:89], 147964 glc
    s_load_dword s47, s[88:89], 148476 glc
    s_load_dword s92, s[88:89], 180732 glc
    s_load_dword s93, s[88:89], 181244 glc
    s_load_dword s94, s[88:89], 213500 glc
    s_load_dword s95, s[88:89], 214012 glc
    s_load_dword s86, s[88:89], 246268 glc
    s_load_dword s87, s[88:89], 246780 glc
    s_waitcnt lgkmcnt(0)
    s_max_u32 s36, s36, s37
    s_max_u32 s36, s36, s38
    s_max_u32 s36, s36, s39
    s_max_u32 s36, s36, s40
    s_max_u32 s36, s36, s41
    s_max_u32 s36, s36, s42
    s_max_u32 s36, s36, s43
    s_max_u32 s36, s36, s46
    s_max_u32 s36, s36, s47
    s_max_u32 s36, s36, s92
    s_max_u32 s36, s36, s93
    s_max_u32 s36, s36, s94
    s_max_u32 s36, s36, s95
    s_max_u32 s36, s36, s86
    s_max_u32 s36, s36, s87
    s_cmp_lg_u32 s36, -1
    s_cbranch_scc1 QD_23
    s_add_u32 s65, s65, 1
    s_cmp_gt_u32 s65, 40
    s_cbranch_scc1 QD_23
    s_sleep 4
    s_branch Q_22
QD_23:
    v_lshlrev_b32 v9, 4, v0
    s_lshl_b32 s68, s76, 10
    s_add_u32 s68, s68, 1703936
    s_mov_b32 s65, 0
P_24:
    s_add_u32 s6, s68, 0
    buffer_load_dwordx4 v[16:19], v9, s[12:15], s6 offen sc1
    s_add_u32 s6, s68, 16384
    buffer_load_dwordx4 v[20:23], v9, s[12:15], s6 offen sc1
    s_add_u32 s6, s68, 32768
    buffer_load_dwordx4 v[24:27], v9, s[12:15], s6 offen sc1
    s_add_u32 s6, s68, 49152
    buffer_load_dwordx4 v[28:31], v9, s[12:15], s6 offen sc1
    s_add_u32 s6, s68, 65536
    buffer_load_dwordx4 v[32:35], v9, s[12:15], s6 offen sc1
    s_add_u32 s6, s68, 81920
    buffer_load_dwordx4 v[36:39], v9, s[12:15], s6 offen sc1
    s_add_u32 s6, s68, 98304
    buffer_load_dwordx4 v[40:43], v9, s[12:15], s6 offen sc1
    s_add_u32 s6, s68, 114688
    buffer_load_dwordx4 v[44:47], v9, s[12:15], s6 offen sc1
    s_add_u32 s6, s68, 131072
    buffer_load_dwordx4 v[48:51], v9, s[12:15], s6 offen sc1
    s_add_u32 s6, s68, 147456
    buffer_load_dwordx4 v[52:55], v9, s[12:15], s6 offen sc1
    s_add_u32 s6, s68, 163840
    buffer_load_dwordx4 v[56:59], v9, s[12:15], s6 offen sc1
    s_add_u32 s6, s68, 180224
    buffer_load_dwordx4 v[60:63], v9, s[12:15], s6 offen sc1
    s_add_u32 s6, s68, 196608
    buffer_load_dwordx4 v[64:67], v9, s[12:15], s6 offen sc1
    s_add_u32 s6, s68, 212992
    buffer_load_dwordx4 v[68:71], v9, s[12:15], s6 offen sc1
    s_add_u32 s6, s68, 229376
    buffer_load_dwordx4 v[72:75], v9, s[12:15], s6 offen sc1
    s_add_u32 s6, s68, 245760
    buffer_load_dwordx4 v[76:79], v9, s[12:15], s6 offen sc1
    s_mov_b64 s[70:71], exec
    s_mov_b64 exec, 1
    ds_add_u32 v1, v2 offset:44
    s_mov_b64 exec, s[70:71]
    s_waitcnt vmcnt(0)
    v_max3_u32 v10, v16, v17, v18
    v_max3_u32 v10, v10, v19, v20
    v_max3_u32 v10, v10, v21, v22
    v_max3_u32 v10, v10, v23, v24
    v_max3_u32 v10, v10, v25, v26
    v_max3_u32 v10, v10, v27, v28
    v_max3_u32 v10, v10, v29, v30
    v_max3_u32 v10, v10, v31, v32
    v_max3_u32 v10, v10, v33, v34
    v_max3_u32 v10, v10, v35, v36
    v_max3_u32 v10, v10, v37, v38
    v_max3_u32 v10, v10, v39, v40
    v_max3_u32 v10, v10, v41, v42
    v_max3_u32 v10, v10, v43, v44
    v_max3_u32 v10, v10, v45, v46
    v_max3_u32 v10, v10, v47, v48
    v_max3_u32 v10, v10, v49, v50
    v_max3_u32 v10, v10, v51, v52
    v_max3_u32 v10, v10, v53, v54
    v_max3_u32 v10, v10, v55, v56
    v_max3_u32 v10, v10, v57, v58
    v_max3_u32 v10, v10, v59, v60
    v_max3_u32 v10, v10, v61, v62
    v_max3_u32 v10, v10, v63, v64
    v_max3_u32 v10, v10, v65, v66
    v_max3_u32 v10, v10, v67, v68
    v_max3_u32 v10, v10, v69, v70
    v_max3_u32 v10, v10, v71, v72
    v_max3_u32 v10, v10, v73, v74
    v_max3_u32 v10, v10, v75, v76
    v_max3_u32 v10, v10, v77, v78
    v_max_u32 v10, v10, v79
    v_cmp_eq_u32 vcc, -1, v10
    s_cbranch_vccz PD_25
    s_add_u32 s65, s65, 1
    s_cmp_gt_u32 s65, 400000
    s_cbranch_scc1 PD_25
    s_sleep 4
    s_branch P_24
PD_25:
    v_add_f32 v16, v16, v48
    v_add_f32 v17, v17, v49
    v_add_f32 v18, v18, v50
    v_add_f32 v19, v19, v51
    v_add_f32 v20, v20, v52
    v_add_f32 v21, v21, v53
    v_add_f32 v22, v22, v54
    v_add_f32 v23, v23, v55
    v_add_f32 v24, v24, v56
    v_add_f32 v25, v25, v57
    v_add_f32 v26, v26, v58
    v_add_f32 v27, v27, v59
    v_add_f32 v28, v28, v60
    v_add_f32 v29, v29, v61
    v_add_f32 v30, v30, v62
    v_add_f32 v31, v31, v63
    v_add_f32 v32, v32, v64
    v_add_f32 v33, v33, v65
    v_add_f32 v34, v34, v66
    v_add_f32 v35, v35, v67
    v_add_f32 v36, v36, v68
    v_add_f32 v37, v37, v69
    v_add_f32 v38, v38, v70
    v_add_f32 v39, v39, v71
    v_add_f32 v40, v40, v72
    v_add_f32 v41, v41, v73
    v_add_f32 v42, v42, v74
    v_add_f32 v43, v43, v75
    v_add_f32 v44, v44, v76
    v_add_f32 v45, v45, v77
    v_add_f32 v46, v46, v78
    v_add_f32 v47, v47, v79
    v_add_f32 v16, v16, v32
    v_add_f32 v17, v17, v33
    v_add_f32 v18, v18, v34
    v_add_f32 v19, v19, v35
    v_add_f32 v20, v20, v36
    v_add_f32 v21, v21, v37
    v_add_f32 v22, v22, v38
    v_add_f32 v23, v23, v39
    v_add_f32 v24, v24, v40
    v_add_f32 v25, v25, v41
    v_add_f32 v26, v26, v42
    v_add_f32 v27, v27, v43
    v_add_f32 v28, v28, v44
    v_add_f32 v29, v29, v45
    v_add_f32 v30, v30, v46
    v_add_f32 v31, v31, v47
    v_add_f32 v16, v16, v24
    v_add_f32 v17, v17, v25
    v_add_f32 v18, v18, v26
    v_add_f32 v19, v19, v27
    v_add_f32 v20, v20, v28
    v_add_f32 v21, v21, v29
    v_add_f32 v22, v22, v30
    v_add_f32 v23, v23, v31
    v_cvt_pk_bf16_f32 v48, v16, v17
    v_cvt_pk_bf16_f32 v49, v18, v19
    v_cvt_pk_bf16_f32 v50, v20, v21
    v_cvt_pk_bf16_f32 v51, v22, v23
    v_lshlrev_b32 v9, 3, v0
    ds_write_b64 v9, v[48:49] offset:256
    ds_write_b64 v9, v[50:51] offset:768
    s_waitcnt lgkmcnt(0)
    s_mov_b64 s[70:71], exec
    s_mov_b64 exec, 1
    ds_add_u32 v1, v2 offset:4
    s_mov_b64 exec, s[70:71]
    s_branch L_aux2
L_job:
    v_lshrrev_b32 v7, 4, v0
    v_and_b32 v9, 1, v0
    v_mul_u32_u24 v9, 1152, v9
    v_lshl_add_u32 v149, v7, 4, v9
    v_lshl_add_u32 v9, v7, 2, v9
    buffer_load_dwordx4 v[140:143], v149, s[8:11], s100 offen
    buffer_load_dwordx4 v[144:147], v149, s[8:11], s100 offen offset:64
    buffer_load_dword v148, v9, s[8:11], s100 offen offset:128
    v_mul_lo_u32 v5, v7, s96
    v_and_b32 v9, 15, v0
    v_lshlrev_b32 v8, 4, v9
    v_lshl_add_u32 v4, v5, 3, v8
    v_lshl_add_u32 v5, v5, 1, v8
    s_mul_i32 s91, s96, 25
    buffer_load_dwordx4 v[16:19], v4, s[16:19], s97 offen nt
    s_add_u32 s97, s97, s96
    buffer_load_dwordx4 v[20:23], v4, s[16:19], s97 offen nt
    s_add_u32 s97, s97, s96
    buffer_load_dwordx4 v[24:27], v4, s[16:19], s97 offen nt
    s_add_u32 s97, s97, s96
    buffer_load_dwordx4 v[28:31], v4, s[16:19], s97 offen nt
    s_add_u32 s97, s97, s96
    buffer_load_dwordx4 v[32:35], v4, s[16:19], s97 offen nt
    s_add_u32 s97, s97, s96
    buffer_load_dwordx4 v[36:39], v4, s[16:19], s97 offen nt
    s_add_u32 s97, s97, s96
    buffer_load_dwordx4 v[40:43], v4, s[16:19], s97 offen nt
    s_add_u32 s97, s97, s96
    buffer_load_dwordx4 v[44:47], v4, s[16:19], s97 offen nt
    s_add_u32 s97, s97, s91
    buffer_load_dwordx4 v[48:51], v4, s[16:19], s97 offen nt
    s_add_u32 s97, s97, s96
    buffer_load_dwordx4 v[52:55], v4, s[16:19], s97 offen nt
    s_add_u32 s97, s97, s96
    buffer_load_dwordx4 v[56:59], v4, s[16:19], s97 offen nt
    s_add_u32 s97, s97, s96
    buffer_load_dwordx4 v[60:63], v4, s[16:19], s97 offen nt
    s_add_u32 s97, s97, s96
    buffer_load_dwordx4 v[64:67], v4, s[16:19], s97 offen nt
    s_add_u32 s97, s97, s96
    buffer_load_dwordx4 v[68:71], v4, s[16:19], s97 offen nt
    s_add_u32 s97, s97, s96
    buffer_load_dwordx4 v[72:75], v4, s[16:19], s97 offen nt
    s_add_u32 s97, s97, s96
    buffer_load_dwordx4 v[76:79], v4, s[16:19], s97 offen nt
    s_add_u32 s97, s97, s91
    buffer_load_dwordx4 v[80:83], v5, s[16:19], s97 offen nt
    s_add_u32 s97, s97, s96
    buffer_load_dwordx4 v[84:87], v5, s[16:19], s97 offen nt
    s_cmp_lg_u32 s79, 0
    s_cbranch_scc1 L_26
    s_barrier
L_26:
    v_lshlrev_b32 v7, 5, v9
    v_mov_b32 v129, 0
    v_mov_b32 v130, 0
    v_mov_b32 v131, 0
    s_add_u32 s99, s99, s98
    s_waitcnt vmcnt(0)
    v_mov_b32 v149, 0
    v_mov_b32 v150, 0
    v_mov_b32 v151, 0
    v_perm_b32 v120, v20, v16, s74
    v_perm_b32 v121, v28, v24, s74
    v_perm_b32 v122, v36, v32, s74
    v_perm_b32 v123, v44, v40, s74
    v_perm_b32 v124, v52, v48, s74
    v_perm_b32 v125, v60, v56, s74
    v_perm_b32 v126, v68, v64, s74
    v_perm_b32 v127, v76, v72, s74
    v_perm_b32 v128, v84, v80, s74
    s_nop 1
    v_mfma_f32_16x16x32_bf16 v[88:91], v[140:143], v[120:123], 0
    v_mfma_f32_16x16x32_bf16 v[88:91], v[144:147], v[124:127], v[88:91]
    v_mfma_f32_16x16x32_bf16 v[88:91], v[148:151], v[128:131], v[88:91]
    v_perm_b32 v120, v20, v16, s75
    v_perm_b32 v121, v28, v24, s75
    v_perm_b32 v122, v36, v32, s75
    v_perm_b32 v123, v44, v40, s75
    v_perm_b32 v124, v52, v48, s75
    v_perm_b32 v125, v60, v56, s75
    v_perm_b32 v126, v68, v64, s75
    v_perm_b32 v127, v76, v72, s75
    v_perm_b32 v128, v84, v80, s75
    s_nop 1
    v_mfma_f32_16x16x32_bf16 v[92:95], v[140:143], v[120:123], 0
    v_mfma_f32_16x16x32_bf16 v[92:95], v[144:147], v[124:127], v[92:95]
    v_mfma_f32_16x16x32_bf16 v[92:95], v[148:151], v[128:131], v[92:95]
    v_perm_b32 v120, v21, v17, s74
    v_perm_b32 v121, v29, v25, s74
    v_perm_b32 v122, v37, v33, s74
    v_perm_b32 v123, v45, v41, s74
    v_perm_b32 v124, v53, v49, s74
    v_perm_b32 v125, v61, v57, s74
    v_perm_b32 v126, v69, v65, s74
    v_perm_b32 v127, v77, v73, s74
    v_perm_b32 v128, v85, v81, s74
    s_nop 1
    v_mfma_f32_16x16x32_bf16 v[96:99], v[140:143], v[120:123], 0
    v_mfma_f32_16x16x32_bf16 v[96:99], v[144:147], v[124:127], v[96:99]
    v_mfma_f32_16x16x32_bf16 v[96:99], v[148:151], v[128:131], v[96:99]
    v_perm_b32 v120, v21, v17, s75
    v_perm_b32 v121, v29, v25, s75
    v_perm_b32 v122, v37, v33, s75
    v_perm_b32 v123, v45, v41, s75
    v_perm_b32 v124, v53, v49, s75
    v_perm_b32 v125, v61, v57, s75
    v_perm_b32 v126, v69, v65, s75
    v_perm_b32 v127, v77, v73, s75
    v_perm_b32 v128, v85, v81, s75
    s_nop 1
    v_mfma_f32_16x16x32_bf16 v[100:103], v[140:143], v[120:123], 0
    v_mfma_f32_16x16x32_bf16 v[100:103], v[144:147], v[124:127], v[100:103]
    v_mfma_f32_16x16x32_bf16 v[100:103], v[148:151], v[128:131], v[100:103]
    v_perm_b32 v120, v22, v18, s74
    v_perm_b32 v121, v30, v26, s74
    v_perm_b32 v122, v38, v34, s74
    v_perm_b32 v123, v46, v42, s74
    v_perm_b32 v124, v54, v50, s74
    v_perm_b32 v125, v62, v58, s74
    v_perm_b32 v126, v70, v66, s74
    v_perm_b32 v127, v78, v74, s74
    v_perm_b32 v128, v86, v82, s74
    s_nop 1
    v_mfma_f32_16x16x32_bf16 v[104:107], v[140:143], v[120:123], 0
    v_mfma_f32_16x16x32_bf16 v[104:107], v[144:147], v[124:127], v[104:107]
    v_mfma_f32_16x16x32_bf16 v[104:107], v[148:151], v[128:131], v[104:107]
    v_perm_b32 v120, v22, v18, s75
    v_perm_b32 v121, v30, v26, s75
    v_perm_b32 v122, v38, v34, s75
    v_perm_b32 v123, v46, v42, s75
    v_perm_b32 v124, v54, v50, s75
    v_perm_b32 v125, v62, v58, s75
    v_perm_b32 v126, v70, v66, s75
    v_perm_b32 v127, v78, v74, s75
    v_perm_b32 v128, v86, v82, s75
    s_nop 1
    v_mfma_f32_16x16x32_bf16 v[108:111], v[140:143], v[120:123], 0
    v_mfma_f32_16x16x32_bf16 v[108:111], v[144:147], v[124:127], v[108:111]
    v_mfma_f32_16x16x32_bf16 v[108:111], v[148:151], v[128:131], v[108:111]
    v_perm_b32 v120, v23, v19, s74
    v_perm_b32 v121, v31, v27, s74
    v_perm_b32 v122, v39, v35, s74
    v_perm_b32 v123, v47, v43, s74
    v_perm_b32 v124, v55, v51, s74
    v_perm_b32 v125, v63, v59, s74
    v_perm_b32 v126, v71, v67, s74
    v_perm_b32 v127, v79, v75, s74
    v_perm_b32 v128, v87, v83, s74
    s_nop 1
    v_mfma_f32_16x16x32_bf16 v[112:115], v[140:143], v[120:123], 0
    v_mfma_f32_16x16x32_bf16 v[112:115], v[144:147], v[124:127], v[112:115]
    v_mfma_f32_16x16x32_bf16 v[112:115], v[148:151], v[128:131], v[112:115]
    v_perm_b32 v120, v23, v19, s75
    v_perm_b32 v121, v31, v27, s75
    v_perm_b32 v122, v39, v35, s75
    v_perm_b32 v123, v47, v43, s75
    v_perm_b32 v124, v55, v51, s75
    v_perm_b32 v125, v63, v59, s75
    v_perm_b32 v126, v71, v67, s75
    v_perm_b32 v127, v79, v75, s75
    v_perm_b32 v128, v87, v83, s75
    s_nop 1
    v_mfma_f32_16x16x32_bf16 v[116:119], v[140:143], v[120:123], 0
    v_mfma_f32_16x16x32_bf16 v[116:119], v[144:147], v[124:127], v[116:119]
    v_mfma_f32_16x16x32_bf16 v[116:119], v[148:151], v[128:131], v[116:119]
    s_mov_b32 s65, 0
W_27:
    ds_read_b32 v12, v1 offset:0
    s_waitcnt lgkmcnt(0)
    v_readfirstlane_b32 s6, v12
    s_cmp_ge_u32 s6, 1
    s_cbranch_scc1 WD_28
    s_add_u32 s65, s65, 1
    s_cmp_gt_u32 s65, 400000
    s_cbranch_scc1 WD_28
    s_sleep 1
    s_branch W_27
WD_28:
    v_min_u32 v152, s78, v88
    v_min_u32 v153, s78, v92
    v_min_u32 v154, s78, v96
    v_min_u32 v155, s78, v100
    v_min_u32 v156, s78, v104
    v_min_u32 v157, s78, v108
    v_min_u32 v158, s78, v112
    v_min_u32 v159, s78, v116
    v_min_u32 v160, s78, v89
    v_min_u32 v161, s78, v93
    v_min_u32 v162, s78, v97
    v_min_u32 v163, s78, v101
    v_min_u32 v164, s78, v105
    v_min_u32 v165, s78, v109
    v_min_u32 v166, s78, v113
    v_min_u32 v167, s78, v117
    s_mov_b64 exec, 0xffff
    buffer_store_dwordx4 v[152:155], v7, s[12:15], s98 offen sc1
    buffer_store_dwordx4 v[156:159], v7, s[12:15], s98 offen offset:16 sc1
    buffer_store_dwordx4 v[160:163], v7, s[12:15], s99 offen sc1
    buffer_store_dwordx4 v[164:167], v7, s[12:15], s99 offen offset:16 sc1
    s_mov_b64 exec, -1
    s_cmp_lg_u32 s79, 0
    s_cbranch_scc1 L_aux2
    s_cmp_ge_u32 s2, 64
    s_cbranch_scc1 L_aux2
    s_mov_b32 s79, 1
    s_add_u32 s66, s2, 512
    s_cmp_ge_u32 s66, 288
    s_cbranch_scc1 L_29
    s_mov_b32 s16, s48
    s_mov_b32 s17, s49
    s_mov_b32 s18, 5308416
    s_mov_b32 s19, 0x20000
    s_mov_b32 s98, 1966080
    s_branch L_30
L_29:
    s_mov_b32 s16, s50
    s_mov_b32 s17, s51
    s_mov_b32 s18, 5308416
    s_mov_b32 s19, 0x20000
    s_mov_b32 s98, 2260992
    s_sub_u32 s66, s66, 288
L_30:
    s_mov_b32 s96, 9216
    s_and_b32 s6, s66, 7
    s_mul_i32 s100, s6, 144
    s_mul_i32 s97, s6, 663552
    s_mul_i32 s6, s6, 36864
    s_add_u32 s98, s98, s6
    s_lshr_b32 s6, s66, 3
    s_lshl_b32 s7, s6, 8
    s_add_u32 s97, s97, s7
    s_lshl_b32 s7, s6, 9
    s_add_u32 s98, s98, s7
    s_mov_b32 s99, 18432
    s_branch L_job
L_aux2:
    s_setprio 0
    s_cmp_eq_u32 s62, 0
    s_cbranch_scc1 L_ffn
    s_cmp_eq_u32 s62, 1
    s_cbranch_scc1 L_wo
    s_cmp_eq_u32 s62, 2
    s_cbranch_scc1 L_red0
    s_endpgm
L_red0:
    s_cmp_eq_u32 s3, 3
    s_cbranch_scc0 L_red
    s_mov_b32 s16, s54
    s_mov_b32 s17, s55
    s_mov_b32 s18, 1152
    s_mov_b32 s19, 0x20000
    v_and_b32 v3, 31, v0
    v_mul_u32_u24 v3, 36, v3
    v_lshrrev_b32 v4, 5, v0
    v_mul_u32_u24 v4, 1152, v4
    v_add_u32 v4, v4, v3
    buffer_load_dword v16, v4, s[8:11], 0 offen offset:0
    buffer_load_dword v32, v3, s[16:19], 0 offen offset:0
    buffer_load_dword v17, v4, s[8:11], 0 offen offset:4
    buffer_load_dword v33, v3, s[16:19], 0 offen offset:4
    buffer_load_dword v18, v4, s[8:11], 0 offen offset:8
    buffer_load_dword v34, v3, s[16:19], 0 offen offset:8
    buffer_load_dword v19, v4, s[8:11], 0 offen offset:12
    buffer_load_dword v35, v3, s[16:19], 0 offen offset:12
    buffer_load_dword v20, v4, s[8:11], 0 offen offset:16
    buffer_load_dword v36, v3, s[16:19], 0 offen offset:16
    buffer_load_dword v21, v4, s[8:11], 0 offen offset:20
    buffer_load_dword v37, v3, s[16:19], 0 offen offset:20
    buffer_load_dword v22, v4, s[8:11], 0 offen offset:24
    buffer_load_dword v38, v3, s[16:19], 0 offen offset:24
    buffer_load_dword v23, v4, s[8:11], 0 offen offset:28
    buffer_load_dword v39, v3, s[16:19], 0 offen offset:28
    buffer_load_dword v24, v4, s[8:11], 0 offen offset:32
    buffer_load_dword v40, v3, s[16:19], 0 offen offset:32
    v_mov_b32 v5, 0
    s_waitcnt vmcnt(0)
    v_lshlrev_b32 v6, 16, v16
    v_and_b32 v7, 0xffff0000, v16
    v_lshlrev_b32 v8, 16, v32
    v_and_b32 v9, 0xffff0000, v32
    v_mul_f32 v6, v6, v8
    v_mul_f32 v7, v7, v9
    v_cvt_pk_bf16_f32 v6, v6, v7
    v_lshlrev_b32 v7, 16, v6
    v_and_b32 v6, 0xffff0000, v6
    v_add_f32 v5, v5, v7
    v_add_f32 v5, v5, v6
    v_lshlrev_b32 v6, 16, v17
    v_and_b32 v7, 0xffff0000, v17
    v_lshlrev_b32 v8, 16, v33
    v_and_b32 v9, 0xffff0000, v33
    v_mul_f32 v6, v6, v8
    v_mul_f32 v7, v7, v9
    v_cvt_pk_bf16_f32 v6, v6, v7
    v_lshlrev_b32 v7, 16, v6
    v_and_b32 v6, 0xffff0000, v6
    v_add_f32 v5, v5, v7
    v_add_f32 v5, v5, v6
    v_lshlrev_b32 v6, 16, v18
    v_and_b32 v7, 0xffff0000, v18
    v_lshlrev_b32 v8, 16, v34
    v_and_b32 v9, 0xffff0000, v34
    v_mul_f32 v6, v6, v8
    v_mul_f32 v7, v7, v9
    v_cvt_pk_bf16_f32 v6, v6, v7
    v_lshlrev_b32 v7, 16, v6
    v_and_b32 v6, 0xffff0000, v6
    v_add_f32 v5, v5, v7
    v_add_f32 v5, v5, v6
    v_lshlrev_b32 v6, 16, v19
    v_and_b32 v7, 0xffff0000, v19
    v_lshlrev_b32 v8, 16, v35
    v_and_b32 v9, 0xffff0000, v35
    v_mul_f32 v6, v6, v8
    v_mul_f32 v7, v7, v9
    v_cvt_pk_bf16_f32 v6, v6, v7
    v_lshlrev_b32 v7, 16, v6
    v_and_b32 v6, 0xffff0000, v6
    v_add_f32 v5, v5, v7
    v_add_f32 v5, v5, v6
    v_lshlrev_b32 v6, 16, v20
    v_and_b32 v7, 0xffff0000, v20
    v_lshlrev_b32 v8, 16, v36
    v_and_b32 v9, 0xffff0000, v36
    v_mul_f32 v6, v6, v8
    v_mul_f32 v7, v7, v9
    v_cvt_pk_bf16_f32 v6, v6, v7
    v_lshlrev_b32 v7, 16, v6
    v_and_b32 v6, 0xffff0000, v6
    v_add_f32 v5, v5, v7
    v_add_f32 v5, v5, v6
    v_lshlrev_b32 v6, 16, v21
    v_and_b32 v7, 0xffff0000, v21
    v_lshlrev_b32 v8, 16, v37
    v_and_b32 v9, 0xffff0000, v37
    v_mul_f32 v6, v6, v8
    v_mul_f32 v7, v7, v9
    v_cvt_pk_bf16_f32 v6, v6, v7
    v_lshlrev_b32 v7, 16, v6
    v_and_b32 v6, 0xffff0000, v6
    v_add_f32 v5, v5, v7
    v_add_f32 v5, v5, v6
    v_lshlrev_b32 v6, 16, v22
    v_and_b32 v7, 0xffff0000, v22
    v_lshlrev_b32 v8, 16, v38
    v_and_b32 v9, 0xffff0000, v38
    v_mul_f32 v6, v6, v8
    v_mul_f32 v7, v7, v9
    v_cvt_pk_bf16_f32 v6, v6, v7
    v_lshlrev_b32 v7, 16, v6
    v_and_b32 v6, 0xffff0000, v6
    v_add_f32 v5, v5, v7
    v_add_f32 v5, v5, v6
    v_lshlrev_b32 v6, 16, v23
    v_and_b32 v7, 0xffff0000, v23
    v_lshlrev_b32 v8, 16, v39
    v_and_b32 v9, 0xffff0000, v39
    v_mul_f32 v6, v6, v8
    v_mul_f32 v7, v7, v9
    v_cvt_pk_bf16_f32 v6, v6, v7
    v_lshlrev_b32 v7, 16, v6
    v_and_b32 v6, 0xffff0000, v6
    v_add_f32 v5, v5, v7
    v_add_f32 v5, v5, v6
    v_lshlrev_b32 v6, 16, v24
    v_and_b32 v7, 0xffff0000, v24
    v_lshlrev_b32 v8, 16, v40
    v_and_b32 v9, 0xffff0000, v40
    v_mul_f32 v6, v6, v8
    v_mul_f32 v7, v7, v9
    v_cvt_pk_bf16_f32 v6, v6, v7
    v_lshlrev_b32 v7, 16, v6
    v_and_b32 v6, 0xffff0000, v6
    v_add_f32 v5, v5, v7
    v_add_f32 v5, v5, v6
    s_nop 1
    v_add_f32_dpp v5, v5, v5 row_ror:1 row_mask:0xf bank_mask:0xf
    s_nop 1
    v_add_f32_dpp v5, v5, v5 row_ror:2 row_mask:0xf bank_mask:0xf
    s_nop 1
    v_add_f32_dpp v5, v5, v5 row_ror:4 row_mask:0xf bank_mask:0xf
    s_nop 1
    v_add_f32_dpp v5, v5, v5 row_ror:8 row_mask:0xf bank_mask:0xf
    v_mov_b32 v6, v5
    s_nop 1
    v_permlane16_swap_b32 v5, v6
    s_nop 0
    v_add_f32 v5, v5, v6
    v_cvt_pk_bf16_f32 v5, v5, v5
    v_and_b32 v5, 0xffff0000, v5
    v_mul_f32 v6, 0xbfb8aa3b, v5
    v_exp_f32 v6, v6
    s_nop 0
    v_add_f32 v6, 1.0, v6
    v_rcp_f32 v6, v6
    s_nop 0
    v_cvt_pk_bf16_f32 v6, v6, v6
    v_and_b32 v6, 0xffff0000, v6
    v_lshrrev_b32 v7, 5, v0
    v_lshlrev_b32 v7, 2, v7
    ds_write_b32 v7, v6 offset:15616
    s_waitcnt lgkmcnt(0)
    s_mov_b64 s[70:71], exec
    s_mov_b64 exec, 1
    ds_add_u32 v1, v2 offset:32
    s_mov_b64 exec, s[70:71]
    s_branch L_red
L_ffn:
    s_branch L_31
L_h:
    s_mov_b32 s65, 0
    v_and_b32 v9, 15, v0
    v_lshlrev_b32 v9, 4, v9
    s_mov_b32 s7, 16
G_32:
    buffer_load_dword v16, v9, s[28:31], 0 offen sc1
    s_waitcnt vmcnt(0)
    v_cmp_gt_u32 vcc, s7, v16
    s_cbranch_vccz GD_33
    s_add_u32 s65, s65, 1
    s_cmp_gt_u32 s65, 400000
    s_cbranch_scc1 GD_33
    s_sleep 16
    s_branch G_32
GD_33:
    v_lshrrev_b32 v9, 5, v0
    s_mov_b32 s6, 18432
    v_mul_lo_u32 v9, v9, s6
    v_and_b32 v10, 31, v0
    v_lshl_add_u32 v9, v10, 2, v9
    s_lshl_b32 s68, s63, 7
    s_add_u32 s68, s68, 1966080
    s_mov_b32 s65, 0
P_34:
    s_add_u32 s6, s68, 0
    buffer_load_dword v16, v9, s[12:15], s6 offen sc1
    s_add_u32 s6, s68, 36864
    buffer_load_dword v17, v9, s[12:15], s6 offen sc1
    s_add_u32 s6, s68, 73728
    buffer_load_dword v18, v9, s[12:15], s6 offen sc1
    s_add_u32 s6, s68, 110592
    buffer_load_dword v19, v9, s[12:15], s6 offen sc1
    s_add_u32 s6, s68, 147456
    buffer_load_dword v20, v9, s[12:15], s6 offen sc1
    s_add_u32 s6, s68, 184320
    buffer_load_dword v21, v9, s[12:15], s6 offen sc1
    s_add_u32 s6, s68, 221184
    buffer_load_dword v22, v9, s[12:15], s6 offen sc1
    s_add_u32 s6, s68, 258048
    buffer_load_dword v23, v9, s[12:15], s6 offen sc1
    s_add_u32 s6, s68, 294912
    buffer_load_dword v24, v9, s[12:15], s6 offen sc1
    s_add_u32 s6, s68, 331776
    buffer_load_dword v25, v9, s[12:15], s6 offen sc1
    s_add_u32 s6, s68, 368640
    buffer_load_dword v26, v9, s[12:15], s6 offen sc1
    s_add_u32 s6, s68, 405504
    buffer_load_dword v27, v9, s[12:15], s6 offen sc1
    s_add_u32 s6, s68, 442368
    buffer_load_dword v28, v9, s[12:15], s6 offen sc1
    s_add_u32 s6, s68, 479232
    buffer_load_dword v29, v9, s[12:15], s6 offen sc1
    s_add_u32 s6, s68, 516096
    buffer_load_dword v30, v9, s[12:15], s6 offen sc1
    s_add_u32 s6, s68, 552960
    buffer_load_dword v31, v9, s[12:15], s6 offen sc1
    s_waitcnt vmcnt(0)
    v_max3_u32 v10, v16, v17, v18
    v_max3_u32 v10, v10, v19, v20
    v_max3_u32 v10, v10, v21, v22
    v_max3_u32 v10, v10, v23, v24
    v_max3_u32 v10, v10, v25, v26
    v_max3_u32 v10, v10, v27, v28
    v_max3_u32 v10, v10, v29, v30
    v_max_u32 v10, v10, v31
    v_cmp_eq_u32 vcc, -1, v10
    s_cbranch_vccz PD_35
    s_add_u32 s65, s65, 1
    s_cmp_gt_u32 s65, 400000
    s_cbranch_scc1 PD_35
    s_sleep 2
    s_branch P_34
PD_35:
    v_add_f32 v16, v16, v20
    v_add_f32 v17, v17, v21
    v_add_f32 v18, v18, v22
    v_add_f32 v19, v19, v23
    v_add_f32 v16, v16, v18
    v_add_f32 v17, v17, v19
    v_add_f32 v16, v16, v17
    v_add_f32 v24, v24, v28
    v_add_f32 v25, v25, v29
    v_add_f32 v26, v26, v30
    v_add_f32 v27, v27, v31
    v_add_f32 v24, v24, v26
    v_add_f32 v25, v25, v27
    v_add_f32 v24, v24, v25
    v_mov_b32 v20, v24
    v_cvt_pk_bf16_f32 v16, v16, v20
    v_and_b32 v20, 0xffff0000, v16
    v_lshlrev_b32 v16, 16, v16
    v_mul_f32 v17, 0xbfb8aa3b, v16
    v_exp_f32 v17, v17
    s_nop 0
    v_add_f32 v17, 1.0, v17
    v_rcp_f32 v17, v17
    s_nop 0
    v_mul_f32 v17, v16, v17
    v_cvt_pk_bf16_f32 v17, v17, v17
    v_and_b32 v17, 0xffff0000, v17
    v_mul_f32 v17, v17, v20
    v_cvt_pk_bf16_f32 v17, v17, v17
    v_lshlrev_b32 v7, 1, v0
    ds_write_b16 v7, v17 offset:14336
    s_waitcnt lgkmcnt(0)
    s_mov_b64 s[70:71], exec
    s_mov_b64 exec, 1
    ds_add_u32 v1, v2 offset:40
    s_mov_b64 exec, s[70:71]
    s_endpgm
L_31:
    s_mov_b32 s20, s52
    s_mov_b32 s21, s53
    s_mov_b32 s22, 5308416
    s_mov_b32 s23, 0x20000
    v_lshrrev_b32 v7, 4, v0
    v_mul_u32_u24 v167, 9216, v7
    v_and_b32 v8, 15, v0
    v_lshl_add_u32 v167, v8, 4, v167
    s_cmp_eq_u32 s3, 4
    s_cselect_b32 s82, 0x00ff00ff, -1
    s_mov_b32 s83, s82
    s_mov_b32 s84, 0xffff
    s_cselect_b32 s84, 0xff, s84
    s_mov_b32 s85, 0
    v_bfe_u32 v7, v0, 2, 2
    s_mov_b32 s6, 26624
    v_mul_lo_u32 v164, v7, s6
    v_and_b32 v8, 3, v0
    v_lshl_add_u32 v164, v8, 5, v164
    s_mul_i32 s66, s63, 36864
    s_lshl_b32 s6, s3, 8
    s_add_u32 s68, s66, s6
    s_mul_i32 s7, s3, 106496
    s_add_u32 s69, s69, s7
    v_and_b32 v8, 1, v0
    v_lshlrev_b32 v8, 6, v8
    v_lshrrev_b32 v9, 4, v0
    v_lshl_add_u32 v11, v9, 4, v8
    s_mov_b32 s65, 0
W_36:
    ds_read_b32 v10, v1 offset:36
    s_waitcnt lgkmcnt(0)
    v_readfirstlane_b32 s6, v10
    s_cmp_ge_u32 s6, 2
    s_cbranch_scc1 WD_37
    s_add_u32 s65, s65, 1
    s_cmp_gt_u32 s65, 400000
    s_cbranch_scc1 WD_37
    s_sleep 1
    s_branch W_36
WD_37:
    s_mov_b64 exec, s[82:83]
    s_add_u32 s6, s68, 0
    buffer_load_dwordx4 v[88:91], v167, s[20:23], s6 offen nt
    s_add_u32 s6, s68, 1152
    buffer_load_dwordx4 v[92:95], v167, s[20:23], s6 offen nt
    s_add_u32 s6, s68, 2304
    buffer_load_dwordx4 v[96:99], v167, s[20:23], s6 offen nt
    s_add_u32 s6, s68, 3456
    buffer_load_dwordx4 v[100:103], v167, s[20:23], s6 offen nt
    s_add_u32 s6, s68, 4608
    buffer_load_dwordx4 v[104:107], v167, s[20:23], s6 offen nt
    s_add_u32 s6, s68, 5760
    buffer_load_dwordx4 v[108:111], v167, s[20:23], s6 offen nt
    s_add_u32 s6, s68, 6912
    buffer_load_dwordx4 v[112:115], v167, s[20:23], s6 offen nt
    s_add_u32 s6, s68, 8064
    buffer_load_dwordx4 v[116:119], v167, s[20:23], s6 offen nt
    s_mov_b64 exec, -1
    s_waitcnt vmcnt(0)
    v_perm_b32 v128, v92, v88, s74
    v_perm_b32 v129, v100, v96, s74
    v_perm_b32 v130, v108, v104, s74
    v_perm_b32 v131, v116, v112, s74
    v_perm_b32 v132, v92, v88, s75
    v_perm_b32 v133, v100, v96, s75
    v_perm_b32 v134, v108, v104, s75
    v_perm_b32 v135, v116, v112, s75
    v_perm_b32 v136, v93, v89, s74
    v_perm_b32 v137, v101, v97, s74
    v_perm_b32 v138, v109, v105, s74
    v_perm_b32 v139, v117, v113, s74
    v_perm_b32 v140, v93, v89, s75
    v_perm_b32 v141, v101, v97, s75
    v_perm_b32 v142, v109, v105, s75
    v_perm_b32 v143, v117, v113, s75
    v_perm_b32 v144, v94, v90, s74
    v_perm_b32 v145, v102, v98, s74
    v_perm_b32 v146, v110, v106, s74
    v_perm_b32 v147, v118, v114, s74
    v_perm_b32 v148, v94, v90, s75
    v_perm_b32 v149, v102, v98, s75
    v_perm_b32 v150, v110, v106, s75
    v_perm_b32 v151, v118, v114, s75
    v_perm_b32 v152, v95, v91, s74
    v_perm_b32 v153, v103, v99, s74
    v_perm_b32 v154, v111, v107, s74
    v_perm_b32 v155, v119, v115, s74
    v_perm_b32 v156, v95, v91, s75
    v_perm_b32 v157, v103, v99, s75
    v_perm_b32 v158, v111, v107, s75
    v_perm_b32 v159, v119, v115, s75
    s_mov_b32 s65, 0
W_38:
    ds_read_b32 v10, v1 offset:40
    s_waitcnt lgkmcnt(0)
    v_readfirstlane_b32 s6, v10
    s_cmp_ge_u32 s6, 1
    s_cbranch_scc1 WD_39
    s_add_u32 s65, s65, 1
    s_cmp_gt_u32 s65, 400000
    s_cbranch_scc1 WD_39
    s_sleep 1
    s_branch W_38
WD_39:
    ds_read_b128 v[120:123], v11 offset:14336
    s_waitcnt lgkmcnt(0)
    v_mfma_f32_16x16x32_bf16 v[16:19], v[120:123], v[128:131], 0
    v_mfma_f32_16x16x32_bf16 v[20:23], v[120:123], v[132:135], 0
    v_mfma_f32_16x16x32_bf16 v[24:27], v[120:123], v[136:139], 0
    v_mfma_f32_16x16x32_bf16 v[28:31], v[120:123], v[140:143], 0
    v_mfma_f32_16x16x32_bf16 v[32:35], v[120:123], v[144:147], 0
    v_mfma_f32_16x16x32_bf16 v[36:39], v[120:123], v[148:151], 0
    v_mfma_f32_16x16x32_bf16 v[40:43], v[120:123], v[152:155], 0
    v_mfma_f32_16x16x32_bf16 v[44:47], v[120:123], v[156:159], 0
    s_nop 0
    v_min_u32 v48, s78, v16
    v_min_u32 v49, s78, v20
    v_min_u32 v50, s78, v24
    v_min_u32 v51, s78, v28
    v_min_u32 v52, s78, v32
    v_min_u32 v53, s78, v36
    v_min_u32 v54, s78, v40
    v_min_u32 v55, s78, v44
    v_min_u32 v56, s78, v17
    v_min_u32 v57, s78, v21
    v_min_u32 v58, s78, v25
    v_min_u32 v59, s78, v29
    v_min_u32 v60, s78, v33
    v_min_u32 v61, s78, v37
    v_min_u32 v62, s78, v41
    v_min_u32 v63, s78, v45
    s_mov_b64 exec, s[84:85]
    s_add_u32 s6, s69, 0
    buffer_store_dwordx4 v[48:51], v164, s[12:15], s6 offen sc1
    buffer_store_dwordx4 v[52:55], v164, s[12:15], s6 offen offset:16 sc1
    s_add_u32 s6, s69, 479232
    buffer_store_dwordx4 v[56:59], v164, s[12:15], s6 offen sc1
    buffer_store_dwordx4 v[60:63], v164, s[12:15], s6 offen offset:16 sc1
    s_mov_b64 exec, -1
    s_endpgm
L_wo:
    s_mov_b32 s20, s44
    s_mov_b32 s21, s45
    s_mov_b32 s22, 4718592
    s_mov_b32 s23, 0x20000
    s_cmp_eq_u32 s3, 4
    s_cselect_b32 s82, 0x00ff00ff, -1
    s_mov_b32 s83, s82
    s_mov_b32 s84, 0xffff
    s_cselect_b32 s84, 0xff, s84
    s_mov_b32 s85, 0
    v_lshrrev_b32 v7, 4, v0
    v_mul_u32_u24 v164, 9216, v7
    v_and_b32 v8, 15, v0
    v_lshl_add_u32 v164, v8, 4, v164
    v_bfe_u32 v7, v0, 2, 2
    s_mov_b32 s6, 26624
    v_mul_lo_u32 v165, v7, s6
    v_and_b32 v8, 3, v0
    v_lshl_add_u32 v165, v8, 5, v165
    s_mul_i32 s66, s63, 73728
    s_lshl_b32 s6, s3, 8
    s_add_u32 s68, s66, s6
    s_add_u32 s67, s68, 36864
    s_mul_i32 s7, s3, 106496
    s_add_u32 s69, s69, s7
    s_mov_b32 s65, 0
W_40:
    ds_read_b32 v10, v1 offset:36
    s_waitcnt lgkmcnt(0)
    v_readfirstlane_b32 s6, v10
    s_cmp_ge_u32 s6, 2
    s_cbranch_scc1 WD_41
    s_add_u32 s65, s65, 1
    s_cmp_gt_u32 s65, 400000
    s_cbranch_scc1 WD_41
    s_sleep 1
    s_branch W_40
WD_41:
    s_mov_b64 exec, s[82:83]
    s_add_u32 s6, s68, 0
    buffer_load_dwordx4 v[16:19], v164, s[20:23], s6 offen nt
    s_add_u32 s6, s68, 1152
    buffer_load_dwordx4 v[20:23], v164, s[20:23], s6 offen nt
    s_add_u32 s6, s68, 2304
    buffer_load_dwordx4 v[24:27], v164, s[20:23], s6 offen nt
    s_add_u32 s6, s68, 3456
    buffer_load_dwordx4 v[28:31], v164, s[20:23], s6 offen nt
    s_add_u32 s6, s68, 4608
    buffer_load_dwordx4 v[32:35], v164, s[20:23], s6 offen nt
    s_add_u32 s6, s68, 5760
    buffer_load_dwordx4 v[36:39], v164, s[20:23], s6 offen nt
    s_add_u32 s6, s68, 6912
    buffer_load_dwordx4 v[40:43], v164, s[20:23], s6 offen nt
    s_add_u32 s6, s68, 8064
    buffer_load_dwordx4 v[44:47], v164, s[20:23], s6 offen nt
    s_add_u32 s6, s67, 0
    buffer_load_dwordx4 v[48:51], v164, s[20:23], s6 offen nt
    s_add_u32 s6, s67, 1152
    buffer_load_dwordx4 v[52:55], v164, s[20:23], s6 offen nt
    s_add_u32 s6, s67, 2304
    buffer_load_dwordx4 v[56:59], v164, s[20:23], s6 offen nt
    s_add_u32 s6, s67, 3456
    buffer_load_dwordx4 v[60:63], v164, s[20:23], s6 offen nt
    s_add_u32 s6, s67, 4608
    buffer_load_dwordx4 v[64:67], v164, s[20:23], s6 offen nt
    s_add_u32 s6, s67, 5760
    buffer_load_dwordx4 v[68:71], v164, s[20:23], s6 offen nt
    s_add_u32 s6, s67, 6912
    buffer_load_dwordx4 v[72:75], v164, s[20:23], s6 offen nt
    s_add_u32 s6, s67, 8064
    buffer_load_dwordx4 v[76:79], v164, s[20:23], s6 offen nt
    s_mov_b64 exec, -1
    v_and_b32 v8, 1, v0
    v_lshlrev_b32 v8, 7, v8
    v_lshrrev_b32 v9, 4, v0
    v_lshl_add_u32 v8, v9, 4, v8
    s_waitcnt vmcnt(8)
    v_perm_b32 v80, v20, v16, s74
    v_perm_b32 v81, v28, v24, s74
    v_perm_b32 v82, v36, v32, s74
    v_perm_b32 v83, v44, v40, s74
    v_perm_b32 v84, v20, v16, s75
    v_perm_b32 v85, v28, v24, s75
    v_perm_b32 v86, v36, v32, s75
    v_perm_b32 v87, v44, v40, s75
    v_perm_b32 v88, v21, v17, s74
    v_perm_b32 v89, v29, v25, s74
    v_perm_b32 v90, v37, v33, s74
    v_perm_b32 v91, v45, v41, s74
    v_perm_b32 v92, v21, v17, s75
    v_perm_b32 v93, v29, v25, s75
    v_perm_b32 v94, v37, v33, s75
    v_perm_b32 v95, v45, v41, s75
    v_perm_b32 v96, v22, v18, s74
    v_perm_b32 v97, v30, v26, s74
    v_perm_b32 v98, v38, v34, s74
    v_perm_b32 v99, v46, v42, s74
    v_perm_b32 v100, v22, v18, s75
    v_perm_b32 v101, v30, v26, s75
    v_perm_b32 v102, v38, v34, s75
    v_perm_b32 v103, v46, v42, s75
    v_perm_b32 v104, v23, v19, s74
    v_perm_b32 v105, v31, v27, s74
    v_perm_b32 v106, v39, v35, s74
    v_perm_b32 v107, v47, v43, s74
    v_perm_b32 v108, v23, v19, s75
    v_perm_b32 v109, v31, v27, s75
    v_perm_b32 v110, v39, v35, s75
    v_perm_b32 v111, v47, v43, s75
    s_waitcnt vmcnt(0)
    v_perm_b32 v16, v52, v48, s74
    v_perm_b32 v17, v60, v56, s74
    v_perm_b32 v18, v68, v64, s74
    v_perm_b32 v19, v76, v72, s74
    v_perm_b32 v20, v52, v48, s75
    v_perm_b32 v21, v60, v56, s75
    v_perm_b32 v22, v68, v64, s75
    v_perm_b32 v23, v76, v72, s75
    v_perm_b32 v24, v53, v49, s74
    v_perm_b32 v25, v61, v57, s74
    v_perm_b32 v26, v69, v65, s74
    v_perm_b32 v27, v77, v73, s74
    v_perm_b32 v28, v53, v49, s75
    v_perm_b32 v29, v61, v57, s75
    v_perm_b32 v30, v69, v65, s75
    v_perm_b32 v31, v77, v73, s75
    v_perm_b32 v32, v54, v50, s74
    v_perm_b32 v33, v62, v58, s74
    v_perm_b32 v34, v70, v66, s74
    v_perm_b32 v35, v78, v74, s74
    v_perm_b32 v36, v54, v50, s75
    v_perm_b32 v37, v62, v58, s75
    v_perm_b32 v38, v70, v66, s75
    v_perm_b32 v39, v78, v74, s75
    v_perm_b32 v40, v55, v51, s74
    v_perm_b32 v41, v63, v59, s74
    v_perm_b32 v42, v71, v67, s74
    v_perm_b32 v43, v79, v75, s74
    v_perm_b32 v44, v55, v51, s75
    v_perm_b32 v45, v63, v59, s75
    v_perm_b32 v46, v71, v67, s75
    v_perm_b32 v47, v79, v75, s75
    s_mov_b32 s65, 0
W_42:
    ds_read_b32 v10, v1 offset:24
    s_waitcnt lgkmcnt(0)
    v_readfirstlane_b32 s6, v10
    s_cmp_ge_u32 s6, 1
    s_cbranch_scc1 WD_43
    s_add_u32 s65, s65, 1
    s_cmp_gt_u32 s65, 400000
    s_cbranch_scc1 WD_43
    s_sleep 1
    s_branch W_42
WD_43:
    ds_read_b128 v[144:147], v8 offset:14848
    ds_read_b128 v[148:151], v8 offset:14912
    s_waitcnt lgkmcnt(0)
    v_mfma_f32_16x16x32_bf16 v[112:115], v[144:147], v[80:83], 0
    v_mfma_f32_16x16x32_bf16 v[116:119], v[144:147], v[84:87], 0
    v_mfma_f32_16x16x32_bf16 v[120:123], v[144:147], v[88:91], 0
    v_mfma_f32_16x16x32_bf16 v[124:127], v[144:147], v[92:95], 0
    v_mfma_f32_16x16x32_bf16 v[128:131], v[144:147], v[96:99], 0
    v_mfma_f32_16x16x32_bf16 v[132:135], v[144:147], v[100:103], 0
    v_mfma_f32_16x16x32_bf16 v[136:139], v[144:147], v[104:107], 0
    v_mfma_f32_16x16x32_bf16 v[140:143], v[144:147], v[108:111], 0
    v_mfma_f32_16x16x32_bf16 v[112:115], v[148:151], v[16:19], v[112:115]
    v_mfma_f32_16x16x32_bf16 v[116:119], v[148:151], v[20:23], v[116:119]
    v_mfma_f32_16x16x32_bf16 v[120:123], v[148:151], v[24:27], v[120:123]
    v_mfma_f32_16x16x32_bf16 v[124:127], v[148:151], v[28:31], v[124:127]
    v_mfma_f32_16x16x32_bf16 v[128:131], v[148:151], v[32:35], v[128:131]
    v_mfma_f32_16x16x32_bf16 v[132:135], v[148:151], v[36:39], v[132:135]
    v_mfma_f32_16x16x32_bf16 v[136:139], v[148:151], v[40:43], v[136:139]
    v_mfma_f32_16x16x32_bf16 v[140:143], v[148:151], v[44:47], v[140:143]
    s_nop 0
    v_min_u32 v48, s78, v112
    v_min_u32 v49, s78, v116
    v_min_u32 v50, s78, v120
    v_min_u32 v51, s78, v124
    v_min_u32 v52, s78, v128
    v_min_u32 v53, s78, v132
    v_min_u32 v54, s78, v136
    v_min_u32 v55, s78, v140
    v_min_u32 v56, s78, v113
    v_min_u32 v57, s78, v117
    v_min_u32 v58, s78, v121
    v_min_u32 v59, s78, v125
    v_min_u32 v60, s78, v129
    v_min_u32 v61, s78, v133
    v_min_u32 v62, s78, v137
    v_min_u32 v63, s78, v141
    s_mov_b64 exec, s[84:85]
    s_add_u32 s6, s69, 0
    buffer_store_dwordx4 v[48:51], v165, s[12:15], s6 offen sc1
    buffer_store_dwordx4 v[52:55], v165, s[12:15], s6 offen offset:16 sc1
    s_add_u32 s6, s69, 479232
    buffer_store_dwordx4 v[56:59], v165, s[12:15], s6 offen sc1
    buffer_store_dwordx4 v[60:63], v165, s[12:15], s6 offen offset:16 sc1
    s_mov_b64 exec, -1
    s_endpgm
L_red:
    s_mov_b32 s32, s56
    s_mov_b32 s33, s57
    s_mov_b32 s34, 2304
    s_mov_b32 s35, 0x20000
    v_lshlrev_b32 v9, 4, v0
    s_mul_i32 s68, s63, 26624
    s_add_u32 s68, s68, 655360
    s_mov_b32 s65, 0
W_44:
    ds_read_b32 v10, v1 offset:4
    s_waitcnt lgkmcnt(0)
    v_readfirstlane_b32 s6, v10
    s_cmp_ge_u32 s6, 1
    s_cbranch_scc1 WD_45
    s_add_u32 s65, s65, 1
    s_cmp_gt_u32 s65, 400000
    s_cbranch_scc1 WD_45
    s_sleep 1
    s_branch W_44
WD_45:
    s_mov_b32 s65, 0
W_46:
    ds_read_b32 v10, v1 offset:12
    s_waitcnt lgkmcnt(0)
    v_readfirstlane_b32 s6, v10
    s_cmp_ge_u32 s6, 4
    s_cbranch_scc1 WD_47
    s_add_u32 s65, s65, 1
    s_cmp_gt_u32 s65, 400000
    s_cbranch_scc1 WD_47
    s_sleep 1
    s_branch W_46
WD_47:
    s_mov_b32 s65, 0
W_48:
    ds_read_b32 v10, v1 offset:16
    s_waitcnt lgkmcnt(0)
    v_readfirstlane_b32 s6, v10
    s_cmp_ge_u32 s6, 4
    s_cbranch_scc1 WD_49
    s_add_u32 s65, s65, 1
    s_cmp_gt_u32 s65, 400000
    s_cbranch_scc1 WD_49
    s_sleep 1
    s_branch W_48
WD_49:
    s_mov_b32 s65, 0
    v_and_b32 v11, 15, v0
    v_lshlrev_b32 v11, 4, v11
    s_mov_b32 s7, 16
G_50:
    buffer_load_dword v16, v11, s[28:31], 0 offen sc1
    s_waitcnt vmcnt(0)
    v_cmp_gt_u32 vcc, s7, v16
    s_cbranch_vccz GD_51
    s_add_u32 s65, s65, 1
    s_cmp_gt_u32 s65, 400000
    s_cbranch_scc1 GD_51
    s_sleep 16
    s_branch G_50
GD_51:
    s_cmp_eq_u32 s3, 0
    s_cbranch_scc0 L_52
    s_mov_b32 s65, 0
P_54:
    s_add_u32 s6, s68, 0
    buffer_load_dwordx4 v[16:19], v9, s[12:15], s6 offen sc1
    s_waitcnt vmcnt(0)
    v_max3_u32 v10, v16, v17, v18
    v_max_u32 v10, v10, v19
    v_cmp_eq_u32 vcc, -1, v10
    s_cbranch_vccz PD_55
    s_add_u32 s65, s65, 1
    s_cmp_gt_u32 s65, 400000
    s_cbranch_scc1 PD_55
    s_sleep 4
    s_branch P_54
PD_55:
    s_mov_b32 s65, 0
P_56:
    s_add_u32 s6, s68, 0
    buffer_load_dwordx4 v[16:19], v9, s[12:15], s6 offen sc1
    s_add_u32 s6, s68, 1024
    buffer_load_dwordx4 v[20:23], v9, s[12:15], s6 offen sc1
    s_add_u32 s6, s68, 2048
    buffer_load_dwordx4 v[24:27], v9, s[12:15], s6 offen sc1
    s_add_u32 s6, s68, 3072
    buffer_load_dwordx4 v[28:31], v9, s[12:15], s6 offen sc1
    s_add_u32 s6, s68, 4096
    buffer_load_dwordx4 v[32:35], v9, s[12:15], s6 offen sc1
    s_add_u32 s6, s68, 5120
    buffer_load_dwordx4 v[36:39], v9, s[12:15], s6 offen sc1
    s_add_u32 s6, s68, 6144
    buffer_load_dwordx4 v[40:43], v9, s[12:15], s6 offen sc1
    s_add_u32 s6, s68, 7168
    buffer_load_dwordx4 v[44:47], v9, s[12:15], s6 offen sc1
    s_waitcnt vmcnt(0)
    v_max3_u32 v10, v16, v17, v18
    v_max3_u32 v10, v10, v19, v20
    v_max3_u32 v10, v10, v21, v22
    v_max3_u32 v10, v10, v23, v24
    v_max3_u32 v10, v10, v25, v26
    v_max3_u32 v10, v10, v27, v28
    v_max3_u32 v10, v10, v29, v30
    v_max3_u32 v10, v10, v31, v32
    v_max3_u32 v10, v10, v33, v34
    v_max3_u32 v10, v10, v35, v36
    v_max3_u32 v10, v10, v37, v38
    v_max3_u32 v10, v10, v39, v40
    v_max3_u32 v10, v10, v41, v42
    v_max3_u32 v10, v10, v43, v44
    v_max3_u32 v10, v10, v45, v46
    v_max_u32 v10, v10, v47
    v_cmp_eq_u32 vcc, -1, v10
    s_cbranch_vccz PD_57
    s_add_u32 s65, s65, 1
    s_cmp_gt_u32 s65, 400000
    s_cbranch_scc1 PD_57
    s_sleep 2
    s_branch P_56
PD_57:
    v_add_f32 v16, v16, v40
    v_add_f32 v17, v17, v41
    v_add_f32 v18, v18, v42
    v_add_f32 v19, v19, v43
    v_add_f32 v20, v20, v44
    v_add_f32 v21, v21, v45
    v_add_f32 v22, v22, v46
    v_add_f32 v23, v23, v47
    s_branch L_53
L_52:
    s_mul_i32 s6, s3, 6144
    s_add_u32 s68, s68, s6
    s_add_u32 s68, s68, 2048
    s_mov_b32 s65, 0
P_58:
    s_add_u32 s6, s68, 0
    buffer_load_dwordx4 v[16:19], v9, s[12:15], s6 offen sc1
    s_waitcnt vmcnt(0)
    v_max3_u32 v10, v16, v17, v18
    v_max_u32 v10, v10, v19
    v_cmp_eq_u32 vcc, -1, v10
    s_cbranch_vccz PD_59
    s_add_u32 s65, s65, 1
    s_cmp_gt_u32 s65, 400000
    s_cbranch_scc1 PD_59
    s_sleep 4
    s_branch P_58
PD_59:
    s_mov_b32 s65, 0
P_60:
    s_add_u32 s6, s68, 0
    buffer_load_dwordx4 v[16:19], v9, s[12:15], s6 offen sc1
    s_add_u32 s6, s68, 1024
    buffer_load_dwordx4 v[20:23], v9, s[12:15], s6 offen sc1
    s_add_u32 s6, s68, 2048
    buffer_load_dwordx4 v[24:27], v9, s[12:15], s6 offen sc1
    s_add_u32 s6, s68, 3072
    buffer_load_dwordx4 v[28:31], v9, s[12:15], s6 offen sc1
    s_add_u32 s6, s68, 4096
    buffer_load_dwordx4 v[32:35], v9, s[12:15], s6 offen sc1
    s_add_u32 s6, s68, 5120
    buffer_load_dwordx4 v[36:39], v9, s[12:15], s6 offen sc1
    s_waitcnt vmcnt(0)
    v_max3_u32 v10, v16, v17, v18
    v_max3_u32 v10, v10, v19, v20
    v_max3_u32 v10, v10, v21, v22
    v_max3_u32 v10, v10, v23, v24
    v_max3_u32 v10, v10, v25, v26
    v_max3_u32 v10, v10, v27, v28
    v_max3_u32 v10, v10, v29, v30
    v_max3_u32 v10, v10, v31, v32
    v_max3_u32 v10, v10, v33, v34
    v_max3_u32 v10, v10, v35, v36
    v_max3_u32 v10, v10, v37, v38
    v_max_u32 v10, v10, v39
    v_cmp_eq_u32 vcc, -1, v10
    s_cbranch_vccz PD_61
    s_add_u32 s65, s65, 1
    s_cmp_gt_u32 s65, 400000
    s_cbranch_scc1 PD_61
    s_sleep 2
    s_branch P_60
PD_61:
L_53:
    v_add_f32 v16, v16, v20
    v_add_f32 v24, v24, v28
    v_add_f32 v32, v32, v36
    v_add_f32 v17, v17, v21
    v_add_f32 v25, v25, v29
    v_add_f32 v33, v33, v37
    v_add_f32 v18, v18, v22
    v_add_f32 v26, v26, v30
    v_add_f32 v34, v34, v38
    v_add_f32 v19, v19, v23
    v_add_f32 v27, v27, v31
    v_add_f32 v35, v35, v39
    v_add_f32 v16, v16, v24
    v_add_f32 v17, v17, v25
    v_add_f32 v18, v18, v26
    v_add_f32 v19, v19, v27
    v_add_f32 v16, v16, v32
    v_add_f32 v17, v17, v33
    v_add_f32 v18, v18, v34
    v_add_f32 v19, v19, v35
    s_nop 1
    v_add_f32_dpp v16, v16, v16 row_ror:8 row_mask:0xf bank_mask:0xf
    v_add_f32_dpp v17, v17, v17 row_ror:8 row_mask:0xf bank_mask:0xf
    v_add_f32_dpp v18, v18, v18 row_ror:8 row_mask:0xf bank_mask:0xf
    v_add_f32_dpp v19, v19, v19 row_ror:8 row_mask:0xf bank_mask:0xf
    v_mov_b32 v20, v16
    v_mov_b32 v21, v17
    v_mov_b32 v22, v18
    v_mov_b32 v23, v19
    s_nop 1
    v_permlane16_swap_b32 v16, v20
    v_permlane16_swap_b32 v17, v21
    v_permlane16_swap_b32 v18, v22
    v_permlane16_swap_b32 v19, v23
    s_nop 0
    v_add_f32 v16, v16, v20
    v_add_f32 v17, v17, v21
    v_add_f32 v18, v18, v22
    v_add_f32 v19, v19, v23
    v_mov_b32 v20, v16
    v_mov_b32 v21, v17
    v_mov_b32 v22, v18
    v_mov_b32 v23, v19
    s_nop 1
    v_permlane32_swap_b32 v16, v20
    v_permlane32_swap_b32 v17, v21
    v_permlane32_swap_b32 v18, v22
    v_permlane32_swap_b32 v19, v23
    s_nop 0
    v_add_f32 v16, v16, v20
    v_add_f32 v17, v17, v21
    v_add_f32 v18, v18, v22
    v_add_f32 v19, v19, v23
    s_lshl_b32 s6, s3, 7
    v_add_u32 v9, s6, v9
    s_mov_b64 exec, 0xff
    ds_write_b128 v9, v[16:19] offset:15104
    s_lshl_b32 s7, 1, s3
    v_mov_b32 v11, s7
    s_mov_b64 exec, 1
    ds_or_rtn_b32 v10, v1, v11 offset:28
    s_mov_b64 exec, -1
    s_waitcnt lgkmcnt(0)
    v_readfirstlane_b32 s6, v10
    s_cmp_eq_u32 s6, 15
    s_cbranch_scc1 L_end
    s_or_b32 s6, s6, s7
    s_cmp_eq_u32 s6, 15
    s_cbranch_scc0 L_end
    s_mov_b32 s65, 0
W_62:
    ds_read_b32 v10, v1 offset:32
    s_waitcnt lgkmcnt(0)
    v_readfirstlane_b32 s6, v10
    s_cmp_ge_u32 s6, 1
    s_cbranch_scc1 WD_63
    s_add_u32 s65, s65, 1
    s_cmp_gt_u32 s65, 400000
    s_cbranch_scc1 WD_63
    s_sleep 1
    s_branch W_62
WD_63:
    v_lshlrev_b32 v9, 2, v0
    ds_read_b32 v16, v9 offset:15104
    ds_read_b32 v17, v9 offset:15232
    ds_read_b32 v18, v9 offset:15360
    ds_read_b32 v19, v9 offset:15488
    s_cmp_ge_u32 s63, 18
    s_cselect_b32 s6, 4, 0
    v_mov_b32 v11, s6
    ds_read_b32 v20, v11 offset:15616
    s_waitcnt lgkmcnt(0)
    v_add_f32 v17, v17, v18
    v_add_f32 v17, v17, v19
    v_sub_f32 v21, 1.0, v20
    v_cvt_pk_bf16_f32 v16, v16, v17
    v_cvt_pk_bf16_f32 v21, v21, v21
    v_and_b32 v17, 0xffff0000, v16
    v_lshlrev_b32 v16, 16, v16
    v_and_b32 v21, 0xffff0000, v21
    v_mul_f32 v16, v20, v16
    v_mul_f32 v17, v21, v17
    v_cvt_pk_bf16_f32 v16, v16, v17
    v_and_b32 v17, 0xffff0000, v16
    v_lshlrev_b32 v16, 16, v16
    v_add_f32 v16, v16, v17
    v_cvt_pk_bf16_f32 v16, v16, v16
    v_lshlrev_b32 v9, 1, v0
    s_lshl_b32 s6, s63, 6
    s_mov_b32 exec_lo, -1
    s_mov_b32 exec_hi, 0
    buffer_store_short v16, v9, s[32:35], s6 offen
    s_endpgm
L_att:
    s_mov_b32 s16, s38
    s_mov_b32 s17, s39
    s_mov_b32 s18, 33554432
    s_mov_b32 s19, 0x20000
    s_mov_b32 s20, s40
    s_mov_b32 s21, s41
    s_mov_b32 s22, 33554432
    s_mov_b32 s23, 0x20000
    s_sub_u32 s66, s3, 4
    s_and_b32 s67, s66, 1
    s_lshr_b32 s68, s66, 1
    s_lshl_b32 s6, s67, 4
    s_add_u32 s6, s6, s76
    s_lshl_b32 s79, s6, 20
    s_lshl_b32 s6, s77, 16
    s_add_u32 s79, s79, s6
    s_lshl_b32 s6, s68, 14
    s_add_u32 s79, s79, s6
    v_and_b32 v3, 15, v0
    v_lshrrev_b32 v4, 4, v0
    v_lshlrev_b32 v5, 8, v3
    v_lshl_add_u32 v5, v4, 4, v5
    v_lshlrev_b32 v6, 10, v4
    v_lshl_add_u32 v6, v3, 4, v6
    s_add_u32 s6, s79, 0
    s_barrier
    buffer_load_dwordx4 v[16:19], v5, s[16:19], s6 offen offset:0 nt
    buffer_load_dwordx4 v[20:23], v5, s[16:19], s6 offen offset:64 nt
    buffer_load_dwordx4 v[24:27], v5, s[16:19], s6 offen offset:128 nt
    buffer_load_dwordx4 v[28:31], v5, s[16:19], s6 offen offset:192 nt
    s_add_u32 s6, s79, 4096
    buffer_load_dwordx4 v[32:35], v5, s[16:19], s6 offen offset:0 nt
    buffer_load_dwordx4 v[36:39], v5, s[16:19], s6 offen offset:64 nt
    buffer_load_dwordx4 v[40:43], v5, s[16:19], s6 offen offset:128 nt
    buffer_load_dwordx4 v[44:47], v5, s[16:19], s6 offen offset:192 nt
    s_add_u32 s6, s79, 8192
    buffer_load_dwordx4 v[48:51], v5, s[16:19], s6 offen offset:0 nt
    buffer_load_dwordx4 v[52:55], v5, s[16:19], s6 offen offset:64 nt
    buffer_load_dwordx4 v[56:59], v5, s[16:19], s6 offen offset:128 nt
    buffer_load_dwordx4 v[60:63], v5, s[16:19], s6 offen offset:192 nt
    s_add_u32 s6, s79, 12288
    buffer_load_dwordx4 v[64:67], v5, s[16:19], s6 offen offset:0 nt
    buffer_load_dwordx4 v[68:71], v5, s[16:19], s6 offen offset:64 nt
    buffer_load_dwordx4 v[72:75], v5, s[16:19], s6 offen offset:128 nt
    buffer_load_dwordx4 v[76:79], v5, s[16:19], s6 offen offset:192 nt
    s_add_u32 s6, s79, 0
    buffer_load_dwordx4 v[80:83], v6, s[20:23], s6 offen offset:0 nt
    buffer_load_dwordx4 v[84:87], v6, s[20:23], s6 offen offset:256 nt
    buffer_load_dwordx4 v[88:91], v6, s[20:23], s6 offen offset:512 nt
    buffer_load_dwordx4 v[92:95], v6, s[20:23], s6 offen offset:768 nt
    s_add_u32 s6, s79, 4096
    buffer_load_dwordx4 v[96:99], v6, s[20:23], s6 offen offset:0 nt
    buffer_load_dwordx4 v[100:103], v6, s[20:23], s6 offen offset:256 nt
    buffer_load_dwordx4 v[104:107], v6, s[20:23], s6 offen offset:512 nt
    buffer_load_dwordx4 v[108:111], v6, s[20:23], s6 offen offset:768 nt
    s_add_u32 s6, s79, 8192
    buffer_load_dwordx4 v[112:115], v6, s[20:23], s6 offen offset:0 nt
    buffer_load_dwordx4 v[116:119], v6, s[20:23], s6 offen offset:256 nt
    buffer_load_dwordx4 v[120:123], v6, s[20:23], s6 offen offset:512 nt
    buffer_load_dwordx4 v[124:127], v6, s[20:23], s6 offen offset:768 nt
    s_add_u32 s6, s79, 12288
    buffer_load_dwordx4 v[128:131], v6, s[20:23], s6 offen offset:0 nt
    buffer_load_dwordx4 v[132:135], v6, s[20:23], s6 offen offset:256 nt
    buffer_load_dwordx4 v[136:139], v6, s[20:23], s6 offen offset:512 nt
    buffer_load_dwordx4 v[140:143], v6, s[20:23], s6 offen offset:768 nt
    s_mov_b64 s[70:71], exec
    s_mov_b64 exec, 1
    ds_add_u32 v1, v2 offset:8
    s_mov_b64 exec, s[70:71]
    v_and_b32 v7, 1, v0
    v_lshlrev_b32 v7, 4, v7
    v_mov_b32 v12, 0xffff
    v_lshlrev_b32 v12, v7, v12
    v_bfe_u32 v7, v0, 1, 2
    v_cmp_eq_u32 vcc, 0, v7
    s_nop 1
    v_cndmask_b32 v8, 0, v12, vcc
    v_cmp_eq_u32 vcc, 1, v7
    s_nop 1
    v_cndmask_b32 v9, 0, v12, vcc
    v_cmp_eq_u32 vcc, 2, v7
    s_nop 1
    v_cndmask_b32 v10, 0, v12, vcc
    v_cmp_eq_u32 vcc, 3, v7
    s_nop 1
    v_cndmask_b32 v11, 0, v12, vcc
    v_bfe_u32 v7, v0, 3, 1
    v_lshlrev_b32 v7, 8, v7
    v_lshl_add_u32 v7, v4, 4, v7
    s_lshl_b32 s6, s67, 9
    v_add_u32 v7, s6, v7
    s_mov_b32 s65, 0
W_64:
    ds_read_b32 v12, v1 offset:4
    s_waitcnt lgkmcnt(0)
    v_readfirstlane_b32 s6, v12
    s_cmp_ge_u32 s6, 1
    s_cbranch_scc1 WD_65
    s_add_u32 s65, s65, 1
    s_cmp_gt_u32 s65, 400000
    s_cbranch_scc1 WD_65
    s_sleep 1
    s_branch W_64
WD_65:
    ds_read_b128 v[144:147], v7 offset:256
    ds_read_b128 v[148:151], v7 offset:320
    ds_read_b128 v[152:155], v7 offset:384
    ds_read_b128 v[156:159], v7 offset:448
    s_waitcnt lgkmcnt(0)
    s_waitcnt vmcnt(28)
    v_mfma_f32_16x16x32_bf16 v[160:163], v[16:19], v[144:147], 0
    v_mfma_f32_16x16x32_bf16 v[160:163], v[20:23], v[148:151], v[160:163]
    v_mfma_f32_16x16x32_bf16 v[160:163], v[24:27], v[152:155], v[160:163]
    v_mfma_f32_16x16x32_bf16 v[160:163], v[28:31], v[156:159], v[160:163]
    s_waitcnt vmcnt(24)
    v_mfma_f32_16x16x32_bf16 v[164:167], v[32:35], v[144:147], 0
    v_mfma_f32_16x16x32_bf16 v[164:167], v[36:39], v[148:151], v[164:167]
    v_mfma_f32_16x16x32_bf16 v[164:167], v[40:43], v[152:155], v[164:167]
    v_mfma_f32_16x16x32_bf16 v[164:167], v[44:47], v[156:159], v[164:167]
    s_waitcnt vmcnt(20)
    v_mfma_f32_16x16x32_bf16 v[16:19], v[48:51], v[144:147], 0
    v_mfma_f32_16x16x32_bf16 v[16:19], v[52:55], v[148:151], v[16:19]
    v_mfma_f32_16x16x32_bf16 v[16:19], v[56:59], v[152:155], v[16:19]
    v_mfma_f32_16x16x32_bf16 v[16:19], v[60:63], v[156:159], v[16:19]
    s_waitcnt vmcnt(16)
    v_mfma_f32_16x16x32_bf16 v[20:23], v[64:67], v[144:147], 0
    v_mfma_f32_16x16x32_bf16 v[20:23], v[68:71], v[148:151], v[20:23]
    v_mfma_f32_16x16x32_bf16 v[20:23], v[72:75], v[152:155], v[20:23]
    v_mfma_f32_16x16x32_bf16 v[20:23], v[76:79], v[156:159], v[20:23]
    s_nop 7
    s_mov_b32 s6, 0x3db504f3
    s_mov_b32 s7, 0x3fb8aa3b
    v_cvt_pk_bf16_f32 v12, v160, v161
    v_lshlrev_b32 v160, 16, v12
    v_and_b32 v161, 0xffff0000, v12
    v_mul_f32 v160, s6, v160
    v_mul_f32 v161, s6, v161
    v_cvt_pk_bf16_f32 v12, v160, v161
    v_lshlrev_b32 v160, 16, v12
    v_and_b32 v161, 0xffff0000, v12
    v_cvt_pk_bf16_f32 v12, v162, v163
    v_lshlrev_b32 v162, 16, v12
    v_and_b32 v163, 0xffff0000, v12
    v_mul_f32 v162, s6, v162
    v_mul_f32 v163, s6, v163
    v_cvt_pk_bf16_f32 v12, v162, v163
    v_lshlrev_b32 v162, 16, v12
    v_and_b32 v163, 0xffff0000, v12
    v_cvt_pk_bf16_f32 v12, v164, v165
    v_lshlrev_b32 v164, 16, v12
    v_and_b32 v165, 0xffff0000, v12
    v_mul_f32 v164, s6, v164
    v_mul_f32 v165, s6, v165
    v_cvt_pk_bf16_f32 v12, v164, v165
    v_lshlrev_b32 v164, 16, v12
    v_and_b32 v165, 0xffff0000, v12
    v_cvt_pk_bf16_f32 v12, v166, v167
    v_lshlrev_b32 v166, 16, v12
    v_and_b32 v167, 0xffff0000, v12
    v_mul_f32 v166, s6, v166
    v_mul_f32 v167, s6, v167
    v_cvt_pk_bf16_f32 v12, v166, v167
    v_lshlrev_b32 v166, 16, v12
    v_and_b32 v167, 0xffff0000, v12
    v_cvt_pk_bf16_f32 v12, v16, v17
    v_lshlrev_b32 v16, 16, v12
    v_and_b32 v17, 0xffff0000, v12
    v_mul_f32 v16, s6, v16
    v_mul_f32 v17, s6, v17
    v_cvt_pk_bf16_f32 v12, v16, v17
    v_lshlrev_b32 v16, 16, v12
    v_and_b32 v17, 0xffff0000, v12
    v_cvt_pk_bf16_f32 v12, v18, v19
    v_lshlrev_b32 v18, 16, v12
    v_and_b32 v19, 0xffff0000, v12
    v_mul_f32 v18, s6, v18
    v_mul_f32 v19, s6, v19
    v_cvt_pk_bf16_f32 v12, v18, v19
    v_lshlrev_b32 v18, 16, v12
    v_and_b32 v19, 0xffff0000, v12
    v_cvt_pk_bf16_f32 v12, v20, v21
    v_lshlrev_b32 v20, 16, v12
    v_and_b32 v21, 0xffff0000, v12
    v_mul_f32 v20, s6, v20
    v_mul_f32 v21, s6, v21
    v_cvt_pk_bf16_f32 v12, v20, v21
    v_lshlrev_b32 v20, 16, v12
    v_and_b32 v21, 0xffff0000, v12
    v_cvt_pk_bf16_f32 v12, v22, v23
    v_lshlrev_b32 v22, 16, v12
    v_and_b32 v23, 0xffff0000, v12
    v_mul_f32 v22, s6, v22
    v_mul_f32 v23, s6, v23
    v_cvt_pk_bf16_f32 v12, v22, v23
    v_lshlrev_b32 v22, 16, v12
    v_and_b32 v23, 0xffff0000, v12
    v_max3_f32 v12, v160, v161, v162
    v_max3_f32 v12, v12, v163, v164
    v_max3_f32 v12, v12, v165, v166
    v_max3_f32 v12, v12, v167, v16
    v_max3_f32 v12, v12, v17, v18
    v_max3_f32 v12, v12, v19, v20
    v_max3_f32 v12, v12, v21, v22
    v_max_f32 v12, v12, v23
    v_mov_b32 v13, v12
    s_nop 1
    v_permlane16_swap_b32 v12, v13
    s_nop 0
    v_max_f32 v12, v12, v13
    v_mov_b32 v13, v12
    s_nop 1
    v_permlane32_swap_b32 v12, v13
    s_nop 0
    v_max_f32 v12, v12, v13
    v_mul_f32 v12, s7, v12
    v_fma_f32 v160, v160, s7, -v12
    v_fma_f32 v161, v161, s7, -v12
    v_fma_f32 v162, v162, s7, -v12
    v_fma_f32 v163, v163, s7, -v12
    v_fma_f32 v164, v164, s7, -v12
    v_fma_f32 v165, v165, s7, -v12
    v_fma_f32 v166, v166, s7, -v12
    v_fma_f32 v167, v167, s7, -v12
    v_fma_f32 v16, v16, s7, -v12
    v_fma_f32 v17, v17, s7, -v12
    v_fma_f32 v18, v18, s7, -v12
    v_fma_f32 v19, v19, s7, -v12
    v_fma_f32 v20, v20, s7, -v12
    v_fma_f32 v21, v21, s7, -v12
    v_fma_f32 v22, v22, s7, -v12
    v_fma_f32 v23, v23, s7, -v12
    v_exp_f32 v160, v160
    v_exp_f32 v161, v161
    v_exp_f32 v162, v162
    v_exp_f32 v163, v163
    v_exp_f32 v164, v164
    v_exp_f32 v165, v165
    v_exp_f32 v166, v166
    v_exp_f32 v167, v167
    v_exp_f32 v16, v16
    v_exp_f32 v17, v17
    v_exp_f32 v18, v18
    v_exp_f32 v19, v19
    v_exp_f32 v20, v20
    v_exp_f32 v21, v21
    v_exp_f32 v22, v22
    v_exp_f32 v23, v23
    s_nop 0
    v_add_f32 v13, v160, v161
    v_add_f32 v13, v13, v162
    v_add_f32 v13, v13, v163
    v_add_f32 v13, v13, v164
    v_add_f32 v13, v13, v165
    v_add_f32 v13, v13, v166
    v_add_f32 v13, v13, v167
    v_add_f32 v13, v13, v16
    v_add_f32 v13, v13, v17
    v_add_f32 v13, v13, v18
    v_add_f32 v13, v13, v19
    v_add_f32 v13, v13, v20
    v_add_f32 v13, v13, v21
    v_add_f32 v13, v13, v22
    v_add_f32 v13, v13, v23
    v_cvt_pk_bf16_f32 v14, v160, v160
    v_and_b32 v24, v14, v8
    v_and_b32 v25, v14, v9
    v_and_b32 v26, v14, v10
    v_and_b32 v27, v14, v11
    v_cvt_pk_bf16_f32 v14, v161, v161
    v_and_b32 v28, v14, v8
    v_and_b32 v29, v14, v9
    v_and_b32 v30, v14, v10
    v_and_b32 v31, v14, v11
    v_cvt_pk_bf16_f32 v14, v162, v162
    v_and_b32 v32, v14, v8
    v_and_b32 v33, v14, v9
    v_and_b32 v34, v14, v10
    v_and_b32 v35, v14, v11
    v_cvt_pk_bf16_f32 v14, v163, v163
    v_and_b32 v36, v14, v8
    v_and_b32 v37, v14, v9
    v_and_b32 v38, v14, v10
    v_and_b32 v39, v14, v11
    v_cvt_pk_bf16_f32 v14, v164, v164
    v_and_b32 v40, v14, v8
    v_and_b32 v41, v14, v9
    v_and_b32 v42, v14, v10
    v_and_b32 v43, v14, v11
    v_cvt_pk_bf16_f32 v14, v165, v165
    v_and_b32 v44, v14, v8
    v_and_b32 v45, v14, v9
    v_and_b32 v46, v14, v10
    v_and_b32 v47, v14, v11
    v_cvt_pk_bf16_f32 v14, v166, v166
    v_and_b32 v48, v14, v8
    v_and_b32 v49, v14, v9
    v_and_b32 v50, v14, v10
    v_and_b32 v51, v14, v11
    v_cvt_pk_bf16_f32 v14, v167, v167
    v_and_b32 v52, v14, v8
    v_and_b32 v53, v14, v9
    v_and_b32 v54, v14, v10
    v_and_b32 v55, v14, v11
    v_cvt_pk_bf16_f32 v14, v16, v16
    v_and_b32 v56, v14, v8
    v_and_b32 v57, v14, v9
    v_and_b32 v58, v14, v10
    v_and_b32 v59, v14, v11
    v_cvt_pk_bf16_f32 v14, v17, v17
    v_and_b32 v60, v14, v8
    v_and_b32 v61, v14, v9
    v_and_b32 v62, v14, v10
    v_and_b32 v63, v14, v11
    v_cvt_pk_bf16_f32 v14, v18, v18
    v_and_b32 v64, v14, v8
    v_and_b32 v65, v14, v9
    v_and_b32 v66, v14, v10
    v_and_b32 v67, v14, v11
    v_cvt_pk_bf16_f32 v14, v19, v19
    v_and_b32 v68, v14, v8
    v_and_b32 v69, v14, v9
    v_and_b32 v70, v14, v10
    v_and_b32 v71, v14, v11
    v_cvt_pk_bf16_f32 v14, v20, v20
    v_and_b32 v72, v14, v8
    v_and_b32 v73, v14, v9
    v_and_b32 v74, v14, v10
    v_and_b32 v75, v14, v11
    v_cvt_pk_bf16_f32 v14, v21, v21
    v_and_b32 v76, v14, v8
    v_and_b32 v77, v14, v9
    v_and_b32 v78, v14, v10
    v_and_b32 v79, v14, v11
    v_cvt_pk_bf16_f32 v14, v22, v22
    v_and_b32 v144, v14, v8
    v_and_b32 v145, v14, v9
    v_and_b32 v146, v14, v10
    v_and_b32 v147, v14, v11
    v_cvt_pk_bf16_f32 v14, v23, v23
    v_and_b32 v148, v14, v8
    v_and_b32 v149, v14, v9
    v_and_b32 v150, v14, v10
    v_and_b32 v151, v14, v11
    v_mov_b32 v14, v13
    s_nop 1
    v_permlane16_swap_b32 v13, v14
    s_nop 0
    v_add_f32 v13, v13, v14
    v_mov_b32 v14, v13
    s_nop 1
    v_permlane32_swap_b32 v13, v14
    s_nop 0
    v_add_f32 v13, v13, v14
    v_bfe_u32 v14, v0, 3, 1
    v_lshlrev_b32 v14, 3, v14
    s_lshl_b32 s6, s66, 4
    v_add_u32 v14, s6, v14
    s_mov_b64 exec, 0x101
    ds_write_b64 v14, v[12:13] offset:1280
    s_mov_b64 exec, -1
    s_waitcnt vmcnt(15)
    v_mfma_f32_16x16x32_bf16 v[152:155], v[24:27], v[80:83], 0
    s_waitcnt vmcnt(14)
    v_mfma_f32_16x16x32_bf16 v[156:159], v[28:31], v[84:87], 0
    s_waitcnt vmcnt(13)
    v_mfma_f32_16x16x32_bf16 v[152:155], v[32:35], v[88:91], v[152:155]
    s_waitcnt vmcnt(12)
    v_mfma_f32_16x16x32_bf16 v[156:159], v[36:39], v[92:95], v[156:159]
    s_waitcnt vmcnt(11)
    v_mfma_f32_16x16x32_bf16 v[152:155], v[40:43], v[96:99], v[152:155]
    s_waitcnt vmcnt(10)
    v_mfma_f32_16x16x32_bf16 v[156:159], v[44:47], v[100:103], v[156:159]
    s_waitcnt vmcnt(9)
    v_mfma_f32_16x16x32_bf16 v[152:155], v[48:51], v[104:107], v[152:155]
    s_waitcnt vmcnt(8)
    v_mfma_f32_16x16x32_bf16 v[156:159], v[52:55], v[108:111], v[156:159]
    s_waitcnt vmcnt(7)
    v_mfma_f32_16x16x32_bf16 v[152:155], v[56:59], v[112:115], v[152:155]
    s_waitcnt vmcnt(6)
    v_mfma_f32_16x16x32_bf16 v[156:159], v[60:63], v[116:119], v[156:159]
    s_waitcnt vmcnt(5)
    v_mfma_f32_16x16x32_bf16 v[152:155], v[64:67], v[120:123], v[152:155]
    s_waitcnt vmcnt(4)
    v_mfma_f32_16x16x32_bf16 v[156:159], v[68:71], v[124:127], v[156:159]
    s_waitcnt vmcnt(3)
    v_mfma_f32_16x16x32_bf16 v[152:155], v[72:75], v[128:131], v[152:155]
    s_waitcnt vmcnt(2)
    v_mfma_f32_16x16x32_bf16 v[156:159], v[76:79], v[132:135], v[156:159]
    s_waitcnt vmcnt(1)
    v_mfma_f32_16x16x32_bf16 v[152:155], v[144:147], v[136:139], v[152:155]
    s_waitcnt vmcnt(0)
    v_mfma_f32_16x16x32_bf16 v[156:159], v[148:151], v[140:143], v[156:159]
    v_lshrrev_b32 v14, 5, v0
    v_lshlrev_b32 v14, 9, v14
    v_lshl_add_u32 v14, v3, 5, v14
    v_and_b32 v15, 1, v4
    v_lshl_add_u32 v14, v15, 4, v14
    s_lshl_b32 s6, s66, 10
    v_add_u32 v14, s6, v14
    s_nop 2
    v_add_f32 v16, v152, v156
    v_add_f32 v17, v153, v157
    v_add_f32 v18, v154, v158
    v_add_f32 v19, v155, v159
    ds_write_b128 v14, v[16:19] offset:2048
    s_lshl_b32 s6, s67, 2
    v_mov_b32 v15, s6
    s_mov_b64 exec, 1
    ds_add_rtn_u32 v14, v15, v2 offset:12
    s_mov_b64 exec, -1
    s_waitcnt lgkmcnt(0)
    v_readfirstlane_b32 s6, v14
    s_cmp_eq_u32 s6, 3
    s_cbranch_scc0 L_att_done
    v_lshrrev_b32 v14, 5, v0
    v_lshlrev_b32 v15, 3, v14
    s_lshl_b32 s6, s67, 4
    v_add_u32 v15, s6, v15
    ds_read_b64 v[16:17], v15 offset:1280
    ds_read_b64 v[18:19], v15 offset:1312
    ds_read_b64 v[20:21], v15 offset:1344
    ds_read_b64 v[22:23], v15 offset:1376
    v_lshlrev_b32 v15, 9, v14
    v_and_b32 v13, 31, v0
    v_lshl_add_u32 v15, v13, 4, v15
    s_lshl_b32 s6, s67, 10
    v_add_u32 v15, s6, v15
    ds_read_b128 v[24:27], v15 offset:2048
    ds_read_b128 v[28:31], v15 offset:4096
    ds_read_b128 v[32:35], v15 offset:6144
    ds_read_b128 v[36:39], v15 offset:8192
    s_waitcnt lgkmcnt(4)
    v_max3_f32 v40, v16, v18, v20
    v_max_f32 v40, v40, v22
    v_sub_f32 v16, v16, v40
    v_sub_f32 v18, v18, v40
    v_sub_f32 v20, v20, v40
    v_sub_f32 v22, v22, v40
    v_exp_f32 v16, v16
    v_exp_f32 v18, v18
    v_exp_f32 v20, v20
    v_exp_f32 v22, v22
    s_nop 0
    v_mul_f32 v41, v16, v17
    v_fmac_f32 v41, v18, v19
    v_fmac_f32 v41, v20, v21
    v_fmac_f32 v41, v22, v23
    s_waitcnt lgkmcnt(0)
    v_mul_f32 v44, v16, v24
    v_fmac_f32 v44, v18, v28
    v_fmac_f32 v44, v20, v32
    v_fmac_f32 v44, v22, v36
    v_mul_f32 v45, v16, v25
    v_fmac_f32 v45, v18, v29
    v_fmac_f32 v45, v20, v33
    v_fmac_f32 v45, v22, v37
    v_mul_f32 v46, v16, v26
    v_fmac_f32 v46, v18, v30
    v_fmac_f32 v46, v20, v34
    v_fmac_f32 v46, v22, v38
    v_mul_f32 v47, v16, v27
    v_fmac_f32 v47, v18, v31
    v_fmac_f32 v47, v20, v35
    v_fmac_f32 v47, v22, v39
    v_min_u32 v44, s78, v44
    v_min_u32 v45, s78, v45
    v_min_u32 v46, s78, v46
    v_min_u32 v47, s78, v47
    v_min_u32 v40, s78, v40
    v_min_u32 v41, s78, v41
    v_lshlrev_b32 v15, 13, v4
    v_lshl_add_u32 v15, v3, 4, v15
    s_lshl_b32 s79, s76, 15
    s_lshl_b32 s6, s77, 9
    s_add_u32 s79, s79, s6
    s_lshl_b32 s6, s67, 8
    s_add_u32 s79, s79, s6
    s_add_u32 s79, s79, 65536
    buffer_store_dwordx4 v[44:47], v15, s[12:15], s79 offen sc1
    v_lshlrev_b32 v15, 8, v14
    s_lshl_b32 s79, s76, 9
    s_lshl_b32 s6, s77, 4
    s_add_u32 s79, s79, s6
    s_lshl_b32 s6, s67, 3
    s_add_u32 s79, s79, s6
    s_add_u32 s79, s79, 589824
    s_mov_b32 exec_lo, 1
    s_mov_b32 exec_hi, 1
    buffer_store_dwordx2 v[40:41], v15, s[12:15], s79 offen sc1
    s_mov_b64 exec, -1
    s_mov_b64 s[70:71], exec
    s_mov_b64 exec, 1
    ds_add_u32 v1, v2 offset:36
    s_mov_b64 exec, s[70:71]
L_att_done:
    s_cmp_eq_u32 s62, 2
    s_cbranch_scc0 L_66
    s_endpgm
L_66:
    s_cmp_eq_u32 s66, 1
    s_cbranch_scc0 L_67
    s_mov_b32 s3, 4
    s_cmp_eq_u32 s62, 0
    s_cbranch_scc1 L_ffn
    s_cmp_eq_u32 s62, 1
    s_cbranch_scc1 L_wo
L_67:
    s_lshr_b32 s6, 1, s66
    s_and_b32 s6, s6, 1
    s_cbranch_scc0 L_end
    s_cmp_eq_u32 s62, 0
    s_cbranch_scc1 L_h
    s_cmp_eq_u32 s62, 1
    s_cbranch_scc0 L_end
    s_lshr_b32 s68, s63, 2
    s_lshl_b32 s68, s68, 4
    s_mov_b32 s65, 0
G_68:
    buffer_load_dword v16, v1, s[28:31], s68 offen sc1
    s_waitcnt vmcnt(0)
    v_readfirstlane_b32 s6, v16
    s_cmp_ge_u32 s6, 16
    s_cbranch_scc1 GD_69
    s_add_u32 s65, s65, 1
    s_cmp_gt_u32 s65, 400000
    s_cbranch_scc1 GD_69
    s_sleep 8
    s_branch G_68
GD_69:
    s_lshr_b32 s6, s63, 1
    s_lshl_b32 s68, s6, 8
    s_add_u32 s68, s68, 589824
    s_lshl_b32 s79, s63, 13
    s_add_u32 s79, s79, 65536
    v_and_b32 v13, 31, v0
    v_lshlrev_b32 v13, 3, v13
    v_lshlrev_b32 v14, 3, v4
    v_lshlrev_b32 v15, 4, v0
    s_mov_b32 s65, 0
P_70:
    buffer_load_dwordx2 v[16:17], v14, s[12:15], s68 offen offset:0 sc1
    buffer_load_dwordx2 v[18:19], v14, s[12:15], s68 offen offset:32 sc1
    buffer_load_dwordx2 v[20:21], v14, s[12:15], s68 offen offset:64 sc1
    buffer_load_dwordx2 v[22:23], v14, s[12:15], s68 offen offset:96 sc1
    buffer_load_dwordx2 v[24:25], v14, s[12:15], s68 offen offset:128 sc1
    buffer_load_dwordx2 v[26:27], v14, s[12:15], s68 offen offset:160 sc1
    buffer_load_dwordx2 v[28:29], v14, s[12:15], s68 offen offset:192 sc1
    buffer_load_dwordx2 v[30:31], v14, s[12:15], s68 offen offset:224 sc1
    s_add_u32 s6, s79, 0
    buffer_load_dwordx4 v[32:35], v15, s[12:15], s6 offen offset:0 sc1
    buffer_load_dwordx4 v[36:39], v15, s[12:15], s6 offen offset:1024 sc1
    buffer_load_dwordx4 v[40:43], v15, s[12:15], s6 offen offset:2048 sc1
    buffer_load_dwordx4 v[44:47], v15, s[12:15], s6 offen offset:3072 sc1
    s_add_u32 s6, s79, 4096
    buffer_load_dwordx4 v[48:51], v15, s[12:15], s6 offen offset:0 sc1
    buffer_load_dwordx4 v[52:55], v15, s[12:15], s6 offen offset:1024 sc1
    buffer_load_dwordx4 v[56:59], v15, s[12:15], s6 offen offset:2048 sc1
    buffer_load_dwordx4 v[60:63], v15, s[12:15], s6 offen offset:3072 sc1
    s_waitcnt vmcnt(0)
    v_max3_u32 v12, v16, v17, v18
    v_max3_u32 v12, v12, v19, v20
    v_max3_u32 v12, v12, v21, v22
    v_max3_u32 v12, v12, v23, v24
    v_max3_u32 v12, v12, v25, v26
    v_max3_u32 v12, v12, v27, v28
    v_max3_u32 v12, v12, v29, v30
    v_max3_u32 v12, v12, v31, v32
    v_max3_u32 v12, v12, v33, v34
    v_max3_u32 v12, v12, v35, v36
    v_max3_u32 v12, v12, v37, v38
    v_max3_u32 v12, v12, v39, v40
    v_max3_u32 v12, v12, v41, v42
    v_max3_u32 v12, v12, v43, v44
    v_max3_u32 v12, v12, v45, v46
    v_max3_u32 v12, v12, v47, v48
    v_max3_u32 v12, v12, v49, v50
    v_max3_u32 v12, v12, v51, v52
    v_max3_u32 v12, v12, v53, v54
    v_max3_u32 v12, v12, v55, v56
    v_max3_u32 v12, v12, v57, v58
    v_max3_u32 v12, v12, v59, v60
    v_max3_u32 v12, v12, v61, v62
    v_max_u32 v12, v12, v63
    v_cmp_eq_u32 vcc, -1, v12
    s_cbranch_vccz PD_71
    s_add_u32 s65, s65, 1
    s_cmp_gt_u32 s65, 400000
    s_cbranch_scc1 PD_71
    s_sleep 1
    s_branch P_70
PD_71:
    v_max3_f32 v12, v16, v18, v20
    v_max3_f32 v12, v12, v22, v24
    v_max3_f32 v12, v12, v26, v28
    v_max_f32 v12, v12, v30
    v_mov_b32 v13, v12
    s_nop 1
    v_permlane32_swap_b32 v12, v13
    s_nop 0
    v_max_f32 v12, v12, v13
    v_sub_f32 v16, v16, v12
    v_sub_f32 v18, v18, v12
    v_sub_f32 v20, v20, v12
    v_sub_f32 v22, v22, v12
    v_sub_f32 v24, v24, v12
    v_sub_f32 v26, v26, v12
    v_sub_f32 v28, v28, v12
    v_sub_f32 v30, v30, v12
    v_exp_f32 v16, v16
    v_exp_f32 v18, v18
    v_exp_f32 v20, v20
    v_exp_f32 v22, v22
    v_exp_f32 v24, v24
    v_exp_f32 v26, v26
    v_exp_f32 v28, v28
    v_exp_f32 v30, v30
    s_nop 0
    v_mul_f32 v64, v16, v17
    v_fmac_f32 v64, v18, v19
    v_fmac_f32 v64, v20, v21
    v_fmac_f32 v64, v22, v23
    v_fmac_f32 v64, v24, v25
    v_fmac_f32 v64, v26, v27
    v_fmac_f32 v64, v28, v29
    v_fmac_f32 v64, v30, v31
    v_mul_f32 v65, v16, v32
    v_fmac_f32 v65, v18, v36
    v_fmac_f32 v65, v20, v40
    v_fmac_f32 v65, v22, v44
    v_fmac_f32 v65, v24, v48
    v_fmac_f32 v65, v26, v52
    v_fmac_f32 v65, v28, v56
    v_fmac_f32 v65, v30, v60
    v_mul_f32 v66, v16, v33
    v_fmac_f32 v66, v18, v37
    v_fmac_f32 v66, v20, v41
    v_fmac_f32 v66, v22, v45
    v_fmac_f32 v66, v24, v49
    v_fmac_f32 v66, v26, v53
    v_fmac_f32 v66, v28, v57
    v_fmac_f32 v66, v30, v61
    v_mul_f32 v67, v16, v34
    v_fmac_f32 v67, v18, v38
    v_fmac_f32 v67, v20, v42
    v_fmac_f32 v67, v22, v46
    v_fmac_f32 v67, v24, v50
    v_fmac_f32 v67, v26, v54
    v_fmac_f32 v67, v28, v58
    v_fmac_f32 v67, v30, v62
    v_mul_f32 v68, v16, v35
    v_fmac_f32 v68, v18, v39
    v_fmac_f32 v68, v20, v43
    v_fmac_f32 v68, v22, v47
    v_fmac_f32 v68, v24, v51
    v_fmac_f32 v68, v26, v55
    v_fmac_f32 v68, v28, v59
    v_fmac_f32 v68, v30, v63
    v_mov_b32 v70, v64
    v_mov_b32 v71, v65
    v_mov_b32 v72, v66
    v_mov_b32 v73, v67
    v_mov_b32 v74, v68
    s_nop 1
    v_permlane32_swap_b32 v64, v70
    v_permlane32_swap_b32 v65, v71
    v_permlane32_swap_b32 v66, v72
    v_permlane32_swap_b32 v67, v73
    v_permlane32_swap_b32 v68, v74
    s_nop 0
    v_add_f32 v64, v64, v70
    v_add_f32 v65, v65, v71
    v_add_f32 v66, v66, v72
    v_add_f32 v67, v67, v73
    v_add_f32 v68, v68, v74
    v_rcp_f32 v64, v64
    s_nop 0
    v_mul_f32 v65, v64, v65
    v_mul_f32 v66, v64, v66
    v_mul_f32 v67, v64, v67
    v_mul_f32 v68, v64, v68
    v_cvt_pk_bf16_f32 v66, v65, v66
    v_cvt_pk_bf16_f32 v67, v67, v68
    v_and_b32 v13, 31, v0
    v_lshlrev_b32 v13, 3, v13
    ds_write_b64 v13, v[66:67] offset:14848
    s_waitcnt lgkmcnt(0)
    s_mov_b64 s[70:71], exec
    s_mov_b64 exec, 1
    ds_add_u32 v1, v2 offset:24
    s_mov_b64 exec, s[70:71]
L_end:
    s_endpgm
.section .rodata,"a"
.p2align 6
.amdhsa_kernel gated_mix__gqa_block_cached__swiglu_ffn__decode_kernel
  .amdhsa_next_free_vgpr 168
  .amdhsa_next_free_sgpr 102
  .amdhsa_accum_offset 168
  .amdhsa_group_segment_fixed_size 0
  .amdhsa_kernarg_size 104
  .amdhsa_user_sgpr_count 2
  .amdhsa_user_sgpr_kernarg_segment_ptr 1
  .amdhsa_system_sgpr_workgroup_id_x 1
.end_amdhsa_kernel
```
